```python
import torch

def _softmax(x, axis=-1):
    return torch.softmax(x, dim=axis)

def _gelu(x):
    return torch.nn.functional.gelu(x, approximate='tanh')

def _silu(x):
    return torch.nn.functional.silu(x)

def _sigmoid(x):
    return torch.sigmoid(x)

def _layernorm(x, axis=-1, eps=1e-05):
    m = x.mean(dim=axis, keepdim=True)
    v = x.var(dim=axis, keepdim=True, unbiased=False)
    return (x - m) / torch.sqrt(v + eps)

def _scatter_add(tgt, idx, src, axis=0):
    return tgt.clone().index_add_(axis, idx, src)

def _segment_sum(src, seg, n):
    out = torch.zeros((n,) + src.shape[1:], dtype=src.dtype)
    return out.index_add_(0, seg, src)

def _pad(x, pw):
    flat = tuple((v for pair in reversed(pw) for v in pair))
    return torch.nn.functional.pad(x, flat)
kernel_name = 'adaLN_cond__mha_block_cached__glu_gated_swiglu__decode'

def setup_inputs():

    _w = lambda a: (lambda t: t.to(torch.bfloat16) if t.is_floating_point() else t)(torch.as_tensor(a))

    def _A_setup():
        B, Sq, D = (2, 1, 512)
        H, Sk, Dh = (32, 8192, 128)
        return {'x': _w((lambda *s: torch.randn(*s, dtype=torch.bfloat16) * 0.1)(B, Sq, D)), 'k_cache': _w((lambda *s: torch.randn(*s, dtype=torch.bfloat16) * 0.8)(B, H, Sk, Dh)), 'v_cache': _w((lambda *s: torch.randn(*s, dtype=torch.bfloat16) * 3.2)(B, H, Sk, Dh)), 'wq': _w((lambda *s: torch.randn(*s, dtype=torch.bfloat16) * 0.8)(D, H * Dh) * D ** (-0.5)), 'wo': _w((lambda *s: torch.randn(*s, dtype=torch.bfloat16) * 3.2)(H * Dh, D) * (H * Dh) ** (-0.5))}
    _A_in = _A_setup()

    def _B_setup():
        B, S, D, F = (2, 1, 512, 1376)
        return {'x': _w((lambda *s: torch.randn(*s, dtype=torch.bfloat16) * 0.1)(B, S, D)), 'w1': _w((lambda *s: torch.randn(*s, dtype=torch.bfloat16) * 3.2)(D, F) * (2.0 / D) ** 0.5), 'w3': _w((lambda *s: torch.randn(*s, dtype=torch.bfloat16) * 3.2)(D, F) * (2.0 / D) ** 0.5), 'w2': _w((lambda *s: torch.randn(*s, dtype=torch.bfloat16) * 3.2)(F, D) * (2.0 / F) ** 0.5)}
    _B_in = _B_setup()
    return {'A_x': _A_in['x'], 'A_k_cache': _A_in['k_cache'], 'A_v_cache': _A_in['v_cache'], 'A_wq': _A_in['wq'], 'A_wo': _A_in['wo'], 'B_x': _B_in['x'], 'B_w1': _B_in['w1'], 'B_w3': _B_in['w3'], 'B_w2': _B_in['w2'], 'c': _w((lambda *s: torch.randn(*s, dtype=torch.bfloat16) * 0.2)(2, 512) * 8.0), 'w_mod': _w((lambda *s: torch.randn(*s, dtype=torch.bfloat16) * 0.2)(512, 6 * 512) * 512 ** (-0.5) * 8.0)}

def reference(A_x, A_k_cache, A_v_cache, A_wq, A_wo, B_x, B_w1, B_w3, B_w2, c, w_mod):

    def _A_ref(x, k_cache, v_cache, wq, wo):
        B, Sq, D = x.shape
        H, Dh = (32, 128)
        q = (lambda x, *d: x.permute(*d))((x @ wq).reshape(B, Sq, H, Dh), 0, 2, 1, 3)
        scores = torch.einsum('bhqd,bhkd->bhqk', q, k_cache) * Dh ** (-0.5)
        p = _softmax(scores, axis=-1)
        o = torch.einsum('bhqk,bhkd->bhqd', p, v_cache)
        return (lambda x, *d: x.permute(*d))(o, 0, 2, 1, 3).reshape(B, Sq, H * Dh) @ wo

    def _B_ref(x, w1, w3, w2):
        gate = torch.einsum('bsd,df->bsf', x, w1)
        up = torch.einsum('bsd,df->bsf', x, w3)
        h = _silu(gate) * up
        out = torch.einsum('bsf,fd->bsd', h, w2)
        return out
    x = A_x
    mod = (_silu(c) @ w_mod).reshape(c.shape[0], 6, 1, -1)
    sa, ca, ga, sb, cb, gb = (mod[:, 0].clone(), mod[:, 1].clone(), mod[:, 2].clone(), mod[:, 3].clone(), mod[:, 4].clone(), mod[:, 5].clone())
    h = _layernorm(x, axis=-1) * (1 + ca) + sa
    x = x + ga * _A_ref(h, A_k_cache, A_v_cache, A_wq, A_wo)
    h = _layernorm(x, axis=-1) * (1 + cb) + sb
    x = x + gb * _B_ref(h, B_w1, B_w3, B_w2)
    return x
```

```asm
; @launch grid=(256,1,1) block=(768,1,1) lds=111872
.amdgcn_target "amdgcn-amd-amdhsa--gfx950"
.text
.globl adaLN_cond__mha_block_cached__glu_gated_swiglu__decode_kernel
.p2align 8
.type adaLN_cond__mha_block_cached__glu_gated_swiglu__decode_kernel,@function
adaLN_cond__mha_block_cached__glu_gated_swiglu__decode_kernel:
    s_cmp_ge_u32 s2, 256
    s_cbranch_scc1 L_end
    s_load_dwordx4 s[4:7], s[0:1], 8
    s_load_dwordx4 s[96:99], s[0:1], 96
    v_lshrrev_b32 v1, 6, v0
    v_and_b32 v2, 63, v0
    v_readfirstlane_b32 s3, v1
    s_lshr_b32 s41, s2, 1
    s_xor_b32 s40, s41, s2
    s_and_b32 s40, s40, 1
    s_and_b32 s41, s41, 3
    s_lshr_b32 s43, s2, 3
    s_lshl_b32 s43, s43, 1
    s_add_u32 s40, s40, s43
    s_lshr_b32 s89, s40, 1
    s_add_u32 s89, s89, s41
    s_and_b32 s89, s89, 3
    s_lshl_b32 s89, s89, 6
    s_add_u32 s89, s89, s40
    s_cmp_ge_u32 s3, 8
    s_cbranch_scc1 L_helper
    v_mov_b32 v34, v2
    s_lshl_b32 s44, s41, 3
    s_add_u32 s44, s44, s3
    s_lshl_b32 s44, s44, 12
    s_mul_i32 s45, s40, 0
    s_lshl_b32 s45, s45, 15
    s_add_u32 s44, s44, s45
    s_lshl_b32 s33, s40, 21
    v_lshlrev_b32 v1, 4, v2
    s_waitcnt lgkmcnt(0)
    s_mov_b32 s8, s4
    s_mov_b32 s9, s5
    s_mov_b32 s10, 134217728
    s_mov_b32 s11, 0x20000
    s_mov_b32 s12, s6
    s_mov_b32 s13, s7
    s_mov_b32 s14, 134217728
    s_mov_b32 s15, 0x20000
    s_add_u32 s16, s44, 0
    s_and_b32 s16, s16, 0x1fffff
    s_add_u32 s16, s16, s33
    buffer_load_dwordx4 v[40:43], v1, s[8:11], s16 offen offset:0 nt
    buffer_load_dwordx4 v[44:47], v1, s[8:11], s16 offen offset:1024 nt
    buffer_load_dwordx4 v[48:51], v1, s[8:11], s16 offen offset:2048 nt
    s_mov_b32 s84, s98
    s_mov_b32 s85, s99
    s_mov_b32 s86, 536870912
    s_mov_b32 s87, 0x20000
    s_barrier
    s_mov_b32 s43, s40
    s_lshl_b32 s45, s43, 3
    s_add_u32 s45, s45, s3
    s_mul_i32 s45, s45, 4224
    s_add_u32 s45, s45, 1048576
    s_lshl_b32 s42, s3, 12
    s_mul_i32 s38, s43, 0
    s_lshl_b32 s38, s38, 15
    s_add_u32 s42, s42, s38
    s_lshl_b32 s43, s43, 21
    s_mov_b32 s32, 0
    s_mov_b32 s28, s32
    s_mov_b32 s29, s32
    s_add_u32 s26, s98, s45
    s_addc_u32 s27, s99, 0
    v_and_b32 v21, 15, v34
    v_and_b32 v22, 1, v34
    v_lshlrev_b32 v22, 4, v22
    s_mov_b32 s17, 0xffff
    v_mov_b32 v23, s17
    v_lshlrev_b32 v22, v22, v23
    v_lshrrev_b32 v21, 1, v21
    v_cmp_eq_u32 vcc, 0, v21
    s_nop 1
    v_cndmask_b32 v6, 0, v22, vcc
    v_cmp_eq_u32 vcc, 1, v21
    s_nop 1
    v_cndmask_b32 v7, 0, v22, vcc
    v_cmp_eq_u32 vcc, 2, v21
    s_nop 1
    v_cndmask_b32 v8, 0, v22, vcc
    v_cmp_eq_u32 vcc, 3, v21
    s_nop 1
    v_cndmask_b32 v9, 0, v22, vcc
    v_mov_b32 v10, 0
    v_mov_b32 v11, 0
    v_mov_b32 v12, 0
    v_mov_b32 v13, 0
    v_mov_b32 v14, 0xff61b1e6
    v_mov_b32 v15, 0
    v_mov_b32 v16, 0
    v_and_b32 v35, 15, v34
    v_lshlrev_b32 v35, 5, v35
    v_lshrrev_b32 v22, 4, v34
    v_and_b32 v23, 1, v22
    v_lshl_add_u32 v35, v23, 4, v35
    v_lshrrev_b32 v22, 1, v22
    v_lshl_add_u32 v35, v22, 9, v35
    s_lshl_b32 s20, s3, 10
    v_add_u32 v35, s20, v35
    s_lshl_b32 s20, s3, 3
    v_mov_b32 v25, s20
    s_mov_b32 s18, 0x3db504f3
    s_mov_b32 s19, 0x3fb8aa3b
    s_waitcnt vmcnt(2)
    buffer_load_dwordx4 v[52:55], v1, s[8:11], s16 offen offset:3072 nt
    s_waitcnt vmcnt(2)
    buffer_load_dwordx4 v[56:59], v1, s[12:15], s16 offen offset:0 nt
    s_waitcnt vmcnt(2)
    buffer_load_dwordx4 v[60:63], v1, s[12:15], s16 offen offset:1024 nt
    s_waitcnt vmcnt(2)
    buffer_load_dwordx4 v[64:67], v1, s[12:15], s16 offen offset:2048 nt
    s_waitcnt vmcnt(2)
    buffer_load_dwordx4 v[68:71], v1, s[12:15], s16 offen offset:3072 nt
    s_waitcnt vmcnt(2)
    s_add_u32 s16, s44, 131072
    s_and_b32 s16, s16, 0x1fffff
    s_add_u32 s16, s16, s33
    buffer_load_dwordx4 v[72:75], v1, s[8:11], s16 offen offset:0 nt
    s_waitcnt vmcnt(2)
    buffer_load_dwordx4 v[76:79], v1, s[8:11], s16 offen offset:1024 nt
    s_waitcnt vmcnt(2)
    buffer_load_dwordx4 v[80:83], v1, s[8:11], s16 offen offset:2048 nt
    s_waitcnt vmcnt(2)
    buffer_load_dwordx4 v[84:87], v1, s[8:11], s16 offen offset:3072 nt
    s_waitcnt vmcnt(2)
    buffer_load_dwordx4 v[88:91], v1, s[12:15], s16 offen offset:0 nt
    s_waitcnt vmcnt(2)
    buffer_load_dwordx4 v[92:95], v1, s[12:15], s16 offen offset:1024 nt
    s_waitcnt vmcnt(2)
    buffer_load_dwordx4 v[96:99], v1, s[12:15], s16 offen offset:2048 nt
    s_waitcnt vmcnt(2)
    buffer_load_dwordx4 v[100:103], v1, s[12:15], s16 offen offset:3072 nt
    s_waitcnt vmcnt(2)
    s_add_u32 s16, s44, 262144
    s_and_b32 s16, s16, 0x1fffff
    s_add_u32 s16, s16, s33
    buffer_load_dwordx4 v[104:107], v1, s[8:11], s16 offen offset:0 nt
    s_waitcnt vmcnt(2)
    buffer_load_dwordx4 v[108:111], v1, s[8:11], s16 offen offset:1024 nt
    s_waitcnt vmcnt(2)
    buffer_load_dwordx4 v[112:115], v1, s[8:11], s16 offen offset:2048 nt
    s_waitcnt vmcnt(2)
    buffer_load_dwordx4 v[116:119], v1, s[8:11], s16 offen offset:3072 nt
    s_waitcnt vmcnt(2)
    buffer_load_dwordx4 v[120:123], v1, s[12:15], s16 offen offset:0 nt
    s_waitcnt vmcnt(2)
    buffer_load_dwordx4 v[124:127], v1, s[12:15], s16 offen offset:1024 nt
    s_waitcnt vmcnt(2)
    buffer_load_dwordx4 v[128:131], v1, s[12:15], s16 offen offset:2048 nt
    s_waitcnt vmcnt(2)
    buffer_load_dwordx4 v[132:135], v1, s[12:15], s16 offen offset:3072 nt
    s_waitcnt vmcnt(2)
    s_add_u32 s16, s44, 393216
    s_and_b32 s16, s16, 0x1fffff
    s_add_u32 s16, s16, s33
    buffer_load_dwordx4 v[136:139], v1, s[8:11], s16 offen offset:0 nt
    s_waitcnt vmcnt(2)
    buffer_load_dwordx4 v[140:143], v1, s[8:11], s16 offen offset:1024 nt
    s_waitcnt vmcnt(2)
    buffer_load_dwordx4 v[144:147], v1, s[8:11], s16 offen offset:2048 nt
    s_waitcnt vmcnt(2)
    buffer_load_dwordx4 v[148:151], v1, s[8:11], s16 offen offset:3072 nt
    s_waitcnt vmcnt(2)
    buffer_load_dwordx4 v[152:155], v1, s[12:15], s16 offen offset:0 nt
    s_waitcnt vmcnt(2)
    buffer_load_dwordx4 v[156:159], v1, s[12:15], s16 offen offset:1024 nt
    s_waitcnt vmcnt(2)
    buffer_load_dwordx4 v[160:163], v1, s[12:15], s16 offen offset:2048 nt
    s_waitcnt vmcnt(2)
    buffer_load_dwordx4 v[164:167], v1, s[12:15], s16 offen offset:3072 nt
    v_and_b32 v21, 15, v34
    v_lshlrev_b32 v21, 4, v21
    s_lshl_b32 s20, s32, 8
    v_add_u32 v21, s20, v21
    v_mov_b32 v22, 0
    s_mov_b32 s88, 0x400000
L_poll_1:
    ds_read_b32 v26, v22 offset:4688
    ds_read_b128 v[2:5], v21 offset:4160
    s_waitcnt lgkmcnt(0)
    v_cmp_eq_u32 vcc, 0, v26
    s_cbranch_vccz L_pdone_2
    s_cmp_eq_u32 s88, 0
    s_cbranch_scc1 L_pdone_2
    s_sub_u32 s88, s88, 1
    s_sleep 1
    s_branch L_poll_1
L_pdone_2:
    v_dot2_f32_bf16 v17, v40, v2, 0
    v_dot2_f32_bf16 v17, v41, v3, v17
    v_dot2_f32_bf16 v17, v42, v4, v17
    v_dot2_f32_bf16 v17, v43, v5, v17
    v_dot2_f32_bf16 v18, v44, v2, 0
    v_dot2_f32_bf16 v18, v45, v3, v18
    v_dot2_f32_bf16 v18, v46, v4, v18
    v_dot2_f32_bf16 v18, v47, v5, v18
    s_waitcnt vmcnt(2)
    s_add_u32 s16, s44, 524288
    s_and_b32 s16, s16, 0x1fffff
    s_add_u32 s16, s16, s33
    buffer_load_dwordx4 v[40:43], v1, s[8:11], s16 offen offset:0 nt
    v_dot2_f32_bf16 v19, v48, v2, 0
    v_dot2_f32_bf16 v19, v49, v3, v19
    v_dot2_f32_bf16 v19, v50, v4, v19
    v_dot2_f32_bf16 v19, v51, v5, v19
    v_dot2_f32_bf16 v20, v52, v2, 0
    v_dot2_f32_bf16 v20, v53, v3, v20
    v_dot2_f32_bf16 v20, v54, v4, v20
    v_dot2_f32_bf16 v20, v55, v5, v20
    s_nop 2
    v_add_f32_dpp v21, v17, v17 row_ror:8 row_mask:0xf bank_mask:0x3
    v_add_f32_dpp v22, v19, v19 row_ror:8 row_mask:0xf bank_mask:0x3
    v_add_f32_dpp v21, v18, v18 row_ror:8 row_mask:0xf bank_mask:0xc
    v_add_f32_dpp v22, v20, v20 row_ror:8 row_mask:0xf bank_mask:0xc
    s_nop 0
    v_add_f32_dpp v23, v21, v21 row_shl:4 row_mask:0xf bank_mask:0x5
    v_add_f32_dpp v23, v22, v22 row_shr:4 row_mask:0xf bank_mask:0xa
    s_nop 1
    v_add_f32_dpp v23, v23, v23 quad_perm:[2,3,0,1] row_mask:0xf bank_mask:0xf
    s_nop 1
    v_add_f32_dpp v23, v23, v23 quad_perm:[1,0,3,2] row_mask:0xf bank_mask:0xf
    v_cvt_pk_bf16_f32 v23, v23, v23
    v_and_b32 v23, 0xffff0000, v23
    v_mul_f32 v23, s18, v23
    v_cvt_pk_bf16_f32 v23, v23, v23
    v_and_b32 v23, 0xffff0000, v23
    v_cmp_gt_f32 vcc, v23, v14
    s_cbranch_vccz L_back_3
    s_call_b64 s[46:47], L_rare
L_back_3:
    v_sub_f32 v21, v23, v14
    v_mul_f32 v21, s19, v21
    v_exp_f32 v21, v21
    s_nop 0
    v_add_f32 v16, v16, v21
    v_cvt_pk_bf16_f32 v24, v21, v21
    s_nop 1
    s_waitcnt vmcnt(2)
    buffer_load_dwordx4 v[44:47], v1, s[8:11], s16 offen offset:1024 nt
    v_and_b32_dpp v26, v24, v6 row_newbcast:0 row_mask:0xf bank_mask:0xf
    v_and_b32_dpp v27, v24, v7 row_newbcast:0 row_mask:0xf bank_mask:0xf
    v_and_b32_dpp v28, v24, v8 row_newbcast:0 row_mask:0xf bank_mask:0xf
    v_and_b32_dpp v29, v24, v9 row_newbcast:0 row_mask:0xf bank_mask:0xf
    s_nop 1
    v_mfma_f32_16x16x32_bf16 v[10:13], v[26:29], v[56:59], v[10:13]
    v_and_b32_dpp v30, v24, v6 row_newbcast:8 row_mask:0xf bank_mask:0xf
    v_and_b32_dpp v31, v24, v7 row_newbcast:8 row_mask:0xf bank_mask:0xf
    v_and_b32_dpp v32, v24, v8 row_newbcast:8 row_mask:0xf bank_mask:0xf
    v_and_b32_dpp v33, v24, v9 row_newbcast:8 row_mask:0xf bank_mask:0xf
    s_nop 1
    v_mfma_f32_16x16x32_bf16 v[10:13], v[30:33], v[60:63], v[10:13]
    s_waitcnt vmcnt(2)
    buffer_load_dwordx4 v[48:51], v1, s[8:11], s16 offen offset:2048 nt
    v_and_b32_dpp v26, v24, v6 row_newbcast:4 row_mask:0xf bank_mask:0xf
    v_and_b32_dpp v27, v24, v7 row_newbcast:4 row_mask:0xf bank_mask:0xf
    v_and_b32_dpp v28, v24, v8 row_newbcast:4 row_mask:0xf bank_mask:0xf
    v_and_b32_dpp v29, v24, v9 row_newbcast:4 row_mask:0xf bank_mask:0xf
    s_nop 1
    v_mfma_f32_16x16x32_bf16 v[10:13], v[26:29], v[64:67], v[10:13]
    v_and_b32_dpp v30, v24, v6 row_newbcast:12 row_mask:0xf bank_mask:0xf
    v_and_b32_dpp v31, v24, v7 row_newbcast:12 row_mask:0xf bank_mask:0xf
    v_and_b32_dpp v32, v24, v8 row_newbcast:12 row_mask:0xf bank_mask:0xf
    v_and_b32_dpp v33, v24, v9 row_newbcast:12 row_mask:0xf bank_mask:0xf
    s_nop 1
    v_mfma_f32_16x16x32_bf16 v[10:13], v[30:33], v[68:71], v[10:13]
    s_waitcnt vmcnt(2)
    buffer_load_dwordx4 v[52:55], v1, s[8:11], s16 offen offset:3072 nt
    v_dot2_f32_bf16 v17, v72, v2, 0
    v_dot2_f32_bf16 v17, v73, v3, v17
    v_dot2_f32_bf16 v17, v74, v4, v17
    v_dot2_f32_bf16 v17, v75, v5, v17
    v_dot2_f32_bf16 v18, v76, v2, 0
    v_dot2_f32_bf16 v18, v77, v3, v18
    v_dot2_f32_bf16 v18, v78, v4, v18
    v_dot2_f32_bf16 v18, v79, v5, v18
    s_waitcnt vmcnt(2)
    buffer_load_dwordx4 v[56:59], v1, s[12:15], s16 offen offset:0 nt
    v_dot2_f32_bf16 v19, v80, v2, 0
    v_dot2_f32_bf16 v19, v81, v3, v19
    v_dot2_f32_bf16 v19, v82, v4, v19
    v_dot2_f32_bf16 v19, v83, v5, v19
    v_dot2_f32_bf16 v20, v84, v2, 0
    v_dot2_f32_bf16 v20, v85, v3, v20
    v_dot2_f32_bf16 v20, v86, v4, v20
    v_dot2_f32_bf16 v20, v87, v5, v20
    s_nop 2
    v_add_f32_dpp v21, v17, v17 row_ror:8 row_mask:0xf bank_mask:0x3
    v_add_f32_dpp v22, v19, v19 row_ror:8 row_mask:0xf bank_mask:0x3
    v_add_f32_dpp v21, v18, v18 row_ror:8 row_mask:0xf bank_mask:0xc
    v_add_f32_dpp v22, v20, v20 row_ror:8 row_mask:0xf bank_mask:0xc
    s_nop 0
    v_add_f32_dpp v23, v21, v21 row_shl:4 row_mask:0xf bank_mask:0x5
    v_add_f32_dpp v23, v22, v22 row_shr:4 row_mask:0xf bank_mask:0xa
    s_nop 1
    v_add_f32_dpp v23, v23, v23 quad_perm:[2,3,0,1] row_mask:0xf bank_mask:0xf
    s_nop 1
    v_add_f32_dpp v23, v23, v23 quad_perm:[1,0,3,2] row_mask:0xf bank_mask:0xf
    v_cvt_pk_bf16_f32 v23, v23, v23
    v_and_b32 v23, 0xffff0000, v23
    v_mul_f32 v23, s18, v23
    v_cvt_pk_bf16_f32 v23, v23, v23
    v_and_b32 v23, 0xffff0000, v23
    v_cmp_gt_f32 vcc, v23, v14
    s_cbranch_vccz L_back_4
    s_call_b64 s[46:47], L_rare
L_back_4:
    v_sub_f32 v21, v23, v14
    v_mul_f32 v21, s19, v21
    v_exp_f32 v21, v21
    s_nop 0
    v_add_f32 v16, v16, v21
    v_cvt_pk_bf16_f32 v24, v21, v21
    s_nop 1
    s_waitcnt vmcnt(2)
    buffer_load_dwordx4 v[60:63], v1, s[12:15], s16 offen offset:1024 nt
    v_and_b32_dpp v26, v24, v6 row_newbcast:0 row_mask:0xf bank_mask:0xf
    v_and_b32_dpp v27, v24, v7 row_newbcast:0 row_mask:0xf bank_mask:0xf
    v_and_b32_dpp v28, v24, v8 row_newbcast:0 row_mask:0xf bank_mask:0xf
    v_and_b32_dpp v29, v24, v9 row_newbcast:0 row_mask:0xf bank_mask:0xf
    s_nop 1
    v_mfma_f32_16x16x32_bf16 v[10:13], v[26:29], v[88:91], v[10:13]
    v_and_b32_dpp v30, v24, v6 row_newbcast:8 row_mask:0xf bank_mask:0xf
    v_and_b32_dpp v31, v24, v7 row_newbcast:8 row_mask:0xf bank_mask:0xf
    v_and_b32_dpp v32, v24, v8 row_newbcast:8 row_mask:0xf bank_mask:0xf
    v_and_b32_dpp v33, v24, v9 row_newbcast:8 row_mask:0xf bank_mask:0xf
    s_nop 1
    v_mfma_f32_16x16x32_bf16 v[10:13], v[30:33], v[92:95], v[10:13]
    s_waitcnt vmcnt(2)
    buffer_load_dwordx4 v[64:67], v1, s[12:15], s16 offen offset:2048 nt
    v_and_b32_dpp v26, v24, v6 row_newbcast:4 row_mask:0xf bank_mask:0xf
    v_and_b32_dpp v27, v24, v7 row_newbcast:4 row_mask:0xf bank_mask:0xf
    v_and_b32_dpp v28, v24, v8 row_newbcast:4 row_mask:0xf bank_mask:0xf
    v_and_b32_dpp v29, v24, v9 row_newbcast:4 row_mask:0xf bank_mask:0xf
    s_nop 1
    v_mfma_f32_16x16x32_bf16 v[10:13], v[26:29], v[96:99], v[10:13]
    v_and_b32_dpp v30, v24, v6 row_newbcast:12 row_mask:0xf bank_mask:0xf
    v_and_b32_dpp v31, v24, v7 row_newbcast:12 row_mask:0xf bank_mask:0xf
    v_and_b32_dpp v32, v24, v8 row_newbcast:12 row_mask:0xf bank_mask:0xf
    v_and_b32_dpp v33, v24, v9 row_newbcast:12 row_mask:0xf bank_mask:0xf
    s_nop 1
    v_mfma_f32_16x16x32_bf16 v[10:13], v[30:33], v[100:103], v[10:13]
    s_waitcnt vmcnt(2)
    buffer_load_dwordx4 v[68:71], v1, s[12:15], s16 offen offset:3072 nt
    v_dot2_f32_bf16 v17, v104, v2, 0
    v_dot2_f32_bf16 v17, v105, v3, v17
    v_dot2_f32_bf16 v17, v106, v4, v17
    v_dot2_f32_bf16 v17, v107, v5, v17
    v_dot2_f32_bf16 v18, v108, v2, 0
    v_dot2_f32_bf16 v18, v109, v3, v18
    v_dot2_f32_bf16 v18, v110, v4, v18
    v_dot2_f32_bf16 v18, v111, v5, v18
    s_waitcnt vmcnt(2)
    s_add_u32 s16, s44, 655360
    s_and_b32 s16, s16, 0x1fffff
    s_add_u32 s16, s16, s33
    buffer_load_dwordx4 v[72:75], v1, s[8:11], s16 offen offset:0 nt
    v_dot2_f32_bf16 v19, v112, v2, 0
    v_dot2_f32_bf16 v19, v113, v3, v19
    v_dot2_f32_bf16 v19, v114, v4, v19
    v_dot2_f32_bf16 v19, v115, v5, v19
    v_dot2_f32_bf16 v20, v116, v2, 0
    v_dot2_f32_bf16 v20, v117, v3, v20
    v_dot2_f32_bf16 v20, v118, v4, v20
    v_dot2_f32_bf16 v20, v119, v5, v20
    s_nop 2
    v_add_f32_dpp v21, v17, v17 row_ror:8 row_mask:0xf bank_mask:0x3
    v_add_f32_dpp v22, v19, v19 row_ror:8 row_mask:0xf bank_mask:0x3
    v_add_f32_dpp v21, v18, v18 row_ror:8 row_mask:0xf bank_mask:0xc
    v_add_f32_dpp v22, v20, v20 row_ror:8 row_mask:0xf bank_mask:0xc
    s_nop 0
    v_add_f32_dpp v23, v21, v21 row_shl:4 row_mask:0xf bank_mask:0x5
    v_add_f32_dpp v23, v22, v22 row_shr:4 row_mask:0xf bank_mask:0xa
    s_nop 1
    v_add_f32_dpp v23, v23, v23 quad_perm:[2,3,0,1] row_mask:0xf bank_mask:0xf
    s_nop 1
    v_add_f32_dpp v23, v23, v23 quad_perm:[1,0,3,2] row_mask:0xf bank_mask:0xf
    v_cvt_pk_bf16_f32 v23, v23, v23
    v_and_b32 v23, 0xffff0000, v23
    v_mul_f32 v23, s18, v23
    v_cvt_pk_bf16_f32 v23, v23, v23
    v_and_b32 v23, 0xffff0000, v23
    v_cmp_gt_f32 vcc, v23, v14
    s_cbranch_vccz L_back_5
    s_call_b64 s[46:47], L_rare
L_back_5:
    v_sub_f32 v21, v23, v14
    v_mul_f32 v21, s19, v21
    v_exp_f32 v21, v21
    s_nop 0
    v_add_f32 v16, v16, v21
    v_cvt_pk_bf16_f32 v24, v21, v21
    s_nop 1
    s_waitcnt vmcnt(2)
    buffer_load_dwordx4 v[76:79], v1, s[8:11], s16 offen offset:1024 nt
    v_and_b32_dpp v26, v24, v6 row_newbcast:0 row_mask:0xf bank_mask:0xf
    v_and_b32_dpp v27, v24, v7 row_newbcast:0 row_mask:0xf bank_mask:0xf
    v_and_b32_dpp v28, v24, v8 row_newbcast:0 row_mask:0xf bank_mask:0xf
    v_and_b32_dpp v29, v24, v9 row_newbcast:0 row_mask:0xf bank_mask:0xf
    s_nop 1
    v_mfma_f32_16x16x32_bf16 v[10:13], v[26:29], v[120:123], v[10:13]
    v_and_b32_dpp v30, v24, v6 row_newbcast:8 row_mask:0xf bank_mask:0xf
    v_and_b32_dpp v31, v24, v7 row_newbcast:8 row_mask:0xf bank_mask:0xf
    v_and_b32_dpp v32, v24, v8 row_newbcast:8 row_mask:0xf bank_mask:0xf
    v_and_b32_dpp v33, v24, v9 row_newbcast:8 row_mask:0xf bank_mask:0xf
    s_nop 1
    v_mfma_f32_16x16x32_bf16 v[10:13], v[30:33], v[124:127], v[10:13]
    s_waitcnt vmcnt(2)
    buffer_load_dwordx4 v[80:83], v1, s[8:11], s16 offen offset:2048 nt
    v_and_b32_dpp v26, v24, v6 row_newbcast:4 row_mask:0xf bank_mask:0xf
    v_and_b32_dpp v27, v24, v7 row_newbcast:4 row_mask:0xf bank_mask:0xf
    v_and_b32_dpp v28, v24, v8 row_newbcast:4 row_mask:0xf bank_mask:0xf
    v_and_b32_dpp v29, v24, v9 row_newbcast:4 row_mask:0xf bank_mask:0xf
    s_nop 1
    v_mfma_f32_16x16x32_bf16 v[10:13], v[26:29], v[128:131], v[10:13]
    v_and_b32_dpp v30, v24, v6 row_newbcast:12 row_mask:0xf bank_mask:0xf
    v_and_b32_dpp v31, v24, v7 row_newbcast:12 row_mask:0xf bank_mask:0xf
    v_and_b32_dpp v32, v24, v8 row_newbcast:12 row_mask:0xf bank_mask:0xf
    v_and_b32_dpp v33, v24, v9 row_newbcast:12 row_mask:0xf bank_mask:0xf
    s_nop 1
    v_mfma_f32_16x16x32_bf16 v[10:13], v[30:33], v[132:135], v[10:13]
    s_waitcnt vmcnt(2)
    buffer_load_dwordx4 v[84:87], v1, s[8:11], s16 offen offset:3072 nt
    v_dot2_f32_bf16 v17, v136, v2, 0
    v_dot2_f32_bf16 v17, v137, v3, v17
    v_dot2_f32_bf16 v17, v138, v4, v17
    v_dot2_f32_bf16 v17, v139, v5, v17
    v_dot2_f32_bf16 v18, v140, v2, 0
    v_dot2_f32_bf16 v18, v141, v3, v18
    v_dot2_f32_bf16 v18, v142, v4, v18
    v_dot2_f32_bf16 v18, v143, v5, v18
    s_waitcnt vmcnt(2)
    buffer_load_dwordx4 v[88:91], v1, s[12:15], s16 offen offset:0 nt
    v_dot2_f32_bf16 v19, v144, v2, 0
    v_dot2_f32_bf16 v19, v145, v3, v19
    v_dot2_f32_bf16 v19, v146, v4, v19
    v_dot2_f32_bf16 v19, v147, v5, v19
    v_dot2_f32_bf16 v20, v148, v2, 0
    v_dot2_f32_bf16 v20, v149, v3, v20
    v_dot2_f32_bf16 v20, v150, v4, v20
    v_dot2_f32_bf16 v20, v151, v5, v20
    s_nop 2
    v_add_f32_dpp v21, v17, v17 row_ror:8 row_mask:0xf bank_mask:0x3
    v_add_f32_dpp v22, v19, v19 row_ror:8 row_mask:0xf bank_mask:0x3
    v_add_f32_dpp v21, v18, v18 row_ror:8 row_mask:0xf bank_mask:0xc
    v_add_f32_dpp v22, v20, v20 row_ror:8 row_mask:0xf bank_mask:0xc
    s_nop 0
    v_add_f32_dpp v23, v21, v21 row_shl:4 row_mask:0xf bank_mask:0x5
    v_add_f32_dpp v23, v22, v22 row_shr:4 row_mask:0xf bank_mask:0xa
    s_nop 1
    v_add_f32_dpp v23, v23, v23 quad_perm:[2,3,0,1] row_mask:0xf bank_mask:0xf
    s_nop 1
    v_add_f32_dpp v23, v23, v23 quad_perm:[1,0,3,2] row_mask:0xf bank_mask:0xf
    v_cvt_pk_bf16_f32 v23, v23, v23
    v_and_b32 v23, 0xffff0000, v23
    v_mul_f32 v23, s18, v23
    v_cvt_pk_bf16_f32 v23, v23, v23
    v_and_b32 v23, 0xffff0000, v23
    v_cmp_gt_f32 vcc, v23, v14
    s_cbranch_vccz L_back_6
    s_call_b64 s[46:47], L_rare
L_back_6:
    v_sub_f32 v21, v23, v14
    v_mul_f32 v21, s19, v21
    v_exp_f32 v21, v21
    s_nop 0
    v_add_f32 v16, v16, v21
    v_cvt_pk_bf16_f32 v24, v21, v21
    s_nop 1
    s_waitcnt vmcnt(2)
    buffer_load_dwordx4 v[92:95], v1, s[12:15], s16 offen offset:1024 nt
    v_and_b32_dpp v26, v24, v6 row_newbcast:0 row_mask:0xf bank_mask:0xf
    v_and_b32_dpp v27, v24, v7 row_newbcast:0 row_mask:0xf bank_mask:0xf
    v_and_b32_dpp v28, v24, v8 row_newbcast:0 row_mask:0xf bank_mask:0xf
    v_and_b32_dpp v29, v24, v9 row_newbcast:0 row_mask:0xf bank_mask:0xf
    s_nop 1
    v_mfma_f32_16x16x32_bf16 v[10:13], v[26:29], v[152:155], v[10:13]
    v_and_b32_dpp v30, v24, v6 row_newbcast:8 row_mask:0xf bank_mask:0xf
    v_and_b32_dpp v31, v24, v7 row_newbcast:8 row_mask:0xf bank_mask:0xf
    v_and_b32_dpp v32, v24, v8 row_newbcast:8 row_mask:0xf bank_mask:0xf
    v_and_b32_dpp v33, v24, v9 row_newbcast:8 row_mask:0xf bank_mask:0xf
    s_nop 1
    v_mfma_f32_16x16x32_bf16 v[10:13], v[30:33], v[156:159], v[10:13]
    s_waitcnt vmcnt(2)
    buffer_load_dwordx4 v[96:99], v1, s[12:15], s16 offen offset:2048 nt
    v_and_b32_dpp v26, v24, v6 row_newbcast:4 row_mask:0xf bank_mask:0xf
    v_and_b32_dpp v27, v24, v7 row_newbcast:4 row_mask:0xf bank_mask:0xf
    v_and_b32_dpp v28, v24, v8 row_newbcast:4 row_mask:0xf bank_mask:0xf
    v_and_b32_dpp v29, v24, v9 row_newbcast:4 row_mask:0xf bank_mask:0xf
    s_nop 1
    v_mfma_f32_16x16x32_bf16 v[10:13], v[26:29], v[160:163], v[10:13]
    v_and_b32_dpp v30, v24, v6 row_newbcast:12 row_mask:0xf bank_mask:0xf
    v_and_b32_dpp v31, v24, v7 row_newbcast:12 row_mask:0xf bank_mask:0xf
    v_and_b32_dpp v32, v24, v8 row_newbcast:12 row_mask:0xf bank_mask:0xf
    v_and_b32_dpp v33, v24, v9 row_newbcast:12 row_mask:0xf bank_mask:0xf
    s_nop 1
    v_mfma_f32_16x16x32_bf16 v[10:13], v[30:33], v[164:167], v[10:13]
    s_waitcnt vmcnt(2)
    buffer_load_dwordx4 v[100:103], v1, s[12:15], s16 offen offset:3072 nt
    v_dot2_f32_bf16 v17, v40, v2, 0
    v_dot2_f32_bf16 v17, v41, v3, v17
    v_dot2_f32_bf16 v17, v42, v4, v17
    v_dot2_f32_bf16 v17, v43, v5, v17
    v_dot2_f32_bf16 v18, v44, v2, 0
    v_dot2_f32_bf16 v18, v45, v3, v18
    v_dot2_f32_bf16 v18, v46, v4, v18
    v_dot2_f32_bf16 v18, v47, v5, v18
    s_waitcnt vmcnt(2)
    s_add_u32 s16, s44, 786432
    s_and_b32 s16, s16, 0x1fffff
    s_add_u32 s16, s16, s33
    buffer_load_dwordx4 v[104:107], v1, s[8:11], s16 offen offset:0 nt
    v_dot2_f32_bf16 v19, v48, v2, 0
    v_dot2_f32_bf16 v19, v49, v3, v19
    v_dot2_f32_bf16 v19, v50, v4, v19
    v_dot2_f32_bf16 v19, v51, v5, v19
    v_dot2_f32_bf16 v20, v52, v2, 0
    v_dot2_f32_bf16 v20, v53, v3, v20
    v_dot2_f32_bf16 v20, v54, v4, v20
    v_dot2_f32_bf16 v20, v55, v5, v20
    s_nop 2
    v_add_f32_dpp v21, v17, v17 row_ror:8 row_mask:0xf bank_mask:0x3
    v_add_f32_dpp v22, v19, v19 row_ror:8 row_mask:0xf bank_mask:0x3
    v_add_f32_dpp v21, v18, v18 row_ror:8 row_mask:0xf bank_mask:0xc
    v_add_f32_dpp v22, v20, v20 row_ror:8 row_mask:0xf bank_mask:0xc
    s_nop 0
    v_add_f32_dpp v23, v21, v21 row_shl:4 row_mask:0xf bank_mask:0x5
    v_add_f32_dpp v23, v22, v22 row_shr:4 row_mask:0xf bank_mask:0xa
    s_nop 1
    v_add_f32_dpp v23, v23, v23 quad_perm:[2,3,0,1] row_mask:0xf bank_mask:0xf
    s_nop 1
    v_add_f32_dpp v23, v23, v23 quad_perm:[1,0,3,2] row_mask:0xf bank_mask:0xf
    v_cvt_pk_bf16_f32 v23, v23, v23
    v_and_b32 v23, 0xffff0000, v23
    v_mul_f32 v23, s18, v23
    v_cvt_pk_bf16_f32 v23, v23, v23
    v_and_b32 v23, 0xffff0000, v23
    v_cmp_gt_f32 vcc, v23, v14
    s_cbranch_vccz L_back_7
    s_call_b64 s[46:47], L_rare
L_back_7:
    v_sub_f32 v21, v23, v14
    v_mul_f32 v21, s19, v21
    v_exp_f32 v21, v21
    s_nop 0
    v_add_f32 v16, v16, v21
    v_cvt_pk_bf16_f32 v24, v21, v21
    s_nop 1
    s_waitcnt vmcnt(2)
    buffer_load_dwordx4 v[108:111], v1, s[8:11], s16 offen offset:1024 nt
    v_and_b32_dpp v26, v24, v6 row_newbcast:0 row_mask:0xf bank_mask:0xf
    v_and_b32_dpp v27, v24, v7 row_newbcast:0 row_mask:0xf bank_mask:0xf
    v_and_b32_dpp v28, v24, v8 row_newbcast:0 row_mask:0xf bank_mask:0xf
    v_and_b32_dpp v29, v24, v9 row_newbcast:0 row_mask:0xf bank_mask:0xf
    s_nop 1
    v_mfma_f32_16x16x32_bf16 v[10:13], v[26:29], v[56:59], v[10:13]
    v_and_b32_dpp v30, v24, v6 row_newbcast:8 row_mask:0xf bank_mask:0xf
    v_and_b32_dpp v31, v24, v7 row_newbcast:8 row_mask:0xf bank_mask:0xf
    v_and_b32_dpp v32, v24, v8 row_newbcast:8 row_mask:0xf bank_mask:0xf
    v_and_b32_dpp v33, v24, v9 row_newbcast:8 row_mask:0xf bank_mask:0xf
    s_nop 1
    v_mfma_f32_16x16x32_bf16 v[10:13], v[30:33], v[60:63], v[10:13]
    s_waitcnt vmcnt(2)
    buffer_load_dwordx4 v[112:115], v1, s[8:11], s16 offen offset:2048 nt
    v_and_b32_dpp v26, v24, v6 row_newbcast:4 row_mask:0xf bank_mask:0xf
    v_and_b32_dpp v27, v24, v7 row_newbcast:4 row_mask:0xf bank_mask:0xf
    v_and_b32_dpp v28, v24, v8 row_newbcast:4 row_mask:0xf bank_mask:0xf
    v_and_b32_dpp v29, v24, v9 row_newbcast:4 row_mask:0xf bank_mask:0xf
    s_nop 1
    v_mfma_f32_16x16x32_bf16 v[10:13], v[26:29], v[64:67], v[10:13]
    v_and_b32_dpp v30, v24, v6 row_newbcast:12 row_mask:0xf bank_mask:0xf
    v_and_b32_dpp v31, v24, v7 row_newbcast:12 row_mask:0xf bank_mask:0xf
    v_and_b32_dpp v32, v24, v8 row_newbcast:12 row_mask:0xf bank_mask:0xf
    v_and_b32_dpp v33, v24, v9 row_newbcast:12 row_mask:0xf bank_mask:0xf
    s_nop 1
    v_mfma_f32_16x16x32_bf16 v[10:13], v[30:33], v[68:71], v[10:13]
    s_waitcnt vmcnt(2)
    buffer_load_dwordx4 v[116:119], v1, s[8:11], s16 offen offset:3072 nt
    v_dot2_f32_bf16 v17, v72, v2, 0
    v_dot2_f32_bf16 v17, v73, v3, v17
    v_dot2_f32_bf16 v17, v74, v4, v17
    v_dot2_f32_bf16 v17, v75, v5, v17
    v_dot2_f32_bf16 v18, v76, v2, 0
    v_dot2_f32_bf16 v18, v77, v3, v18
    v_dot2_f32_bf16 v18, v78, v4, v18
    v_dot2_f32_bf16 v18, v79, v5, v18
    s_waitcnt vmcnt(2)
    buffer_load_dwordx4 v[120:123], v1, s[12:15], s16 offen offset:0 nt
    v_dot2_f32_bf16 v19, v80, v2, 0
    v_dot2_f32_bf16 v19, v81, v3, v19
    v_dot2_f32_bf16 v19, v82, v4, v19
    v_dot2_f32_bf16 v19, v83, v5, v19
    v_dot2_f32_bf16 v20, v84, v2, 0
    v_dot2_f32_bf16 v20, v85, v3, v20
    v_dot2_f32_bf16 v20, v86, v4, v20
    v_dot2_f32_bf16 v20, v87, v5, v20
    s_nop 2
    v_add_f32_dpp v21, v17, v17 row_ror:8 row_mask:0xf bank_mask:0x3
    v_add_f32_dpp v22, v19, v19 row_ror:8 row_mask:0xf bank_mask:0x3
    v_add_f32_dpp v21, v18, v18 row_ror:8 row_mask:0xf bank_mask:0xc
    v_add_f32_dpp v22, v20, v20 row_ror:8 row_mask:0xf bank_mask:0xc
    s_nop 0
    v_add_f32_dpp v23, v21, v21 row_shl:4 row_mask:0xf bank_mask:0x5
    v_add_f32_dpp v23, v22, v22 row_shr:4 row_mask:0xf bank_mask:0xa
    s_nop 1
    v_add_f32_dpp v23, v23, v23 quad_perm:[2,3,0,1] row_mask:0xf bank_mask:0xf
    s_nop 1
    v_add_f32_dpp v23, v23, v23 quad_perm:[1,0,3,2] row_mask:0xf bank_mask:0xf
    v_cvt_pk_bf16_f32 v23, v23, v23
    v_and_b32 v23, 0xffff0000, v23
    v_mul_f32 v23, s18, v23
    v_cvt_pk_bf16_f32 v23, v23, v23
    v_and_b32 v23, 0xffff0000, v23
    v_cmp_gt_f32 vcc, v23, v14
    s_cbranch_vccz L_back_8
    s_call_b64 s[46:47], L_rare
L_back_8:
    v_sub_f32 v21, v23, v14
    v_mul_f32 v21, s19, v21
    v_exp_f32 v21, v21
    s_nop 0
    v_add_f32 v16, v16, v21
    v_cvt_pk_bf16_f32 v24, v21, v21
    s_nop 1
    s_waitcnt vmcnt(2)
    buffer_load_dwordx4 v[124:127], v1, s[12:15], s16 offen offset:1024 nt
    v_and_b32_dpp v26, v24, v6 row_newbcast:0 row_mask:0xf bank_mask:0xf
    v_and_b32_dpp v27, v24, v7 row_newbcast:0 row_mask:0xf bank_mask:0xf
    v_and_b32_dpp v28, v24, v8 row_newbcast:0 row_mask:0xf bank_mask:0xf
    v_and_b32_dpp v29, v24, v9 row_newbcast:0 row_mask:0xf bank_mask:0xf
    s_nop 1
    v_mfma_f32_16x16x32_bf16 v[10:13], v[26:29], v[88:91], v[10:13]
    v_and_b32_dpp v30, v24, v6 row_newbcast:8 row_mask:0xf bank_mask:0xf
    v_and_b32_dpp v31, v24, v7 row_newbcast:8 row_mask:0xf bank_mask:0xf
    v_and_b32_dpp v32, v24, v8 row_newbcast:8 row_mask:0xf bank_mask:0xf
    v_and_b32_dpp v33, v24, v9 row_newbcast:8 row_mask:0xf bank_mask:0xf
    s_nop 1
    v_mfma_f32_16x16x32_bf16 v[10:13], v[30:33], v[92:95], v[10:13]
    s_waitcnt vmcnt(2)
    buffer_load_dwordx4 v[128:131], v1, s[12:15], s16 offen offset:2048 nt
    v_and_b32_dpp v26, v24, v6 row_newbcast:4 row_mask:0xf bank_mask:0xf
    v_and_b32_dpp v27, v24, v7 row_newbcast:4 row_mask:0xf bank_mask:0xf
    v_and_b32_dpp v28, v24, v8 row_newbcast:4 row_mask:0xf bank_mask:0xf
    v_and_b32_dpp v29, v24, v9 row_newbcast:4 row_mask:0xf bank_mask:0xf
    s_nop 1
    v_mfma_f32_16x16x32_bf16 v[10:13], v[26:29], v[96:99], v[10:13]
    v_and_b32_dpp v30, v24, v6 row_newbcast:12 row_mask:0xf bank_mask:0xf
    v_and_b32_dpp v31, v24, v7 row_newbcast:12 row_mask:0xf bank_mask:0xf
    v_and_b32_dpp v32, v24, v8 row_newbcast:12 row_mask:0xf bank_mask:0xf
    v_and_b32_dpp v33, v24, v9 row_newbcast:12 row_mask:0xf bank_mask:0xf
    s_nop 1
    v_mfma_f32_16x16x32_bf16 v[10:13], v[30:33], v[100:103], v[10:13]
    s_waitcnt vmcnt(2)
    buffer_load_dwordx4 v[132:135], v1, s[12:15], s16 offen offset:3072 nt
    v_dot2_f32_bf16 v17, v104, v2, 0
    v_dot2_f32_bf16 v17, v105, v3, v17
    v_dot2_f32_bf16 v17, v106, v4, v17
    v_dot2_f32_bf16 v17, v107, v5, v17
    v_dot2_f32_bf16 v18, v108, v2, 0
    v_dot2_f32_bf16 v18, v109, v3, v18
    v_dot2_f32_bf16 v18, v110, v4, v18
    v_dot2_f32_bf16 v18, v111, v5, v18
    s_waitcnt vmcnt(2)
    s_add_u32 s16, s44, 917504
    s_and_b32 s16, s16, 0x1fffff
    s_add_u32 s16, s16, s33
    buffer_load_dwordx4 v[136:139], v1, s[8:11], s16 offen offset:0 nt
    v_dot2_f32_bf16 v19, v112, v2, 0
    v_dot2_f32_bf16 v19, v113, v3, v19
    v_dot2_f32_bf16 v19, v114, v4, v19
    v_dot2_f32_bf16 v19, v115, v5, v19
    v_dot2_f32_bf16 v20, v116, v2, 0
    v_dot2_f32_bf16 v20, v117, v3, v20
    v_dot2_f32_bf16 v20, v118, v4, v20
    v_dot2_f32_bf16 v20, v119, v5, v20
    s_nop 2
    v_add_f32_dpp v21, v17, v17 row_ror:8 row_mask:0xf bank_mask:0x3
    v_add_f32_dpp v22, v19, v19 row_ror:8 row_mask:0xf bank_mask:0x3
    v_add_f32_dpp v21, v18, v18 row_ror:8 row_mask:0xf bank_mask:0xc
    v_add_f32_dpp v22, v20, v20 row_ror:8 row_mask:0xf bank_mask:0xc
    s_nop 0
    v_add_f32_dpp v23, v21, v21 row_shl:4 row_mask:0xf bank_mask:0x5
    v_add_f32_dpp v23, v22, v22 row_shr:4 row_mask:0xf bank_mask:0xa
    s_nop 1
    v_add_f32_dpp v23, v23, v23 quad_perm:[2,3,0,1] row_mask:0xf bank_mask:0xf
    s_nop 1
    v_add_f32_dpp v23, v23, v23 quad_perm:[1,0,3,2] row_mask:0xf bank_mask:0xf
    v_cvt_pk_bf16_f32 v23, v23, v23
    v_and_b32 v23, 0xffff0000, v23
    v_mul_f32 v23, s18, v23
    v_cvt_pk_bf16_f32 v23, v23, v23
    v_and_b32 v23, 0xffff0000, v23
    v_cmp_gt_f32 vcc, v23, v14
    s_cbranch_vccz L_back_9
    s_call_b64 s[46:47], L_rare
L_back_9:
    v_sub_f32 v21, v23, v14
    v_mul_f32 v21, s19, v21
    v_exp_f32 v21, v21
    s_nop 0
    v_add_f32 v16, v16, v21
    v_cvt_pk_bf16_f32 v24, v21, v21
    s_nop 1
    s_waitcnt vmcnt(2)
    buffer_load_dwordx4 v[140:143], v1, s[8:11], s16 offen offset:1024 nt
    v_and_b32_dpp v26, v24, v6 row_newbcast:0 row_mask:0xf bank_mask:0xf
    v_and_b32_dpp v27, v24, v7 row_newbcast:0 row_mask:0xf bank_mask:0xf
    v_and_b32_dpp v28, v24, v8 row_newbcast:0 row_mask:0xf bank_mask:0xf
    v_and_b32_dpp v29, v24, v9 row_newbcast:0 row_mask:0xf bank_mask:0xf
    s_nop 1
    v_mfma_f32_16x16x32_bf16 v[10:13], v[26:29], v[120:123], v[10:13]
    v_and_b32_dpp v30, v24, v6 row_newbcast:8 row_mask:0xf bank_mask:0xf
    v_and_b32_dpp v31, v24, v7 row_newbcast:8 row_mask:0xf bank_mask:0xf
    v_and_b32_dpp v32, v24, v8 row_newbcast:8 row_mask:0xf bank_mask:0xf
    v_and_b32_dpp v33, v24, v9 row_newbcast:8 row_mask:0xf bank_mask:0xf
    s_nop 1
    v_mfma_f32_16x16x32_bf16 v[10:13], v[30:33], v[124:127], v[10:13]
    s_waitcnt vmcnt(2)
    buffer_load_dwordx4 v[144:147], v1, s[8:11], s16 offen offset:2048 nt
    v_and_b32_dpp v26, v24, v6 row_newbcast:4 row_mask:0xf bank_mask:0xf
    v_and_b32_dpp v27, v24, v7 row_newbcast:4 row_mask:0xf bank_mask:0xf
    v_and_b32_dpp v28, v24, v8 row_newbcast:4 row_mask:0xf bank_mask:0xf
    v_and_b32_dpp v29, v24, v9 row_newbcast:4 row_mask:0xf bank_mask:0xf
    s_nop 1
    v_mfma_f32_16x16x32_bf16 v[10:13], v[26:29], v[128:131], v[10:13]
    v_and_b32_dpp v30, v24, v6 row_newbcast:12 row_mask:0xf bank_mask:0xf
    v_and_b32_dpp v31, v24, v7 row_newbcast:12 row_mask:0xf bank_mask:0xf
    v_and_b32_dpp v32, v24, v8 row_newbcast:12 row_mask:0xf bank_mask:0xf
    v_and_b32_dpp v33, v24, v9 row_newbcast:12 row_mask:0xf bank_mask:0xf
    s_nop 1
    v_mfma_f32_16x16x32_bf16 v[10:13], v[30:33], v[132:135], v[10:13]
    s_waitcnt vmcnt(2)
    buffer_load_dwordx4 v[148:151], v1, s[8:11], s16 offen offset:3072 nt
    v_dot2_f32_bf16 v17, v136, v2, 0
    v_dot2_f32_bf16 v17, v137, v3, v17
    v_dot2_f32_bf16 v17, v138, v4, v17
    v_dot2_f32_bf16 v17, v139, v5, v17
    s_waitcnt vmcnt(2)
    buffer_load_dwordx4 v[152:155], v1, s[12:15], s16 offen offset:0 nt
    v_dot2_f32_bf16 v18, v140, v2, 0
    v_dot2_f32_bf16 v18, v141, v3, v18
    v_dot2_f32_bf16 v18, v142, v4, v18
    v_dot2_f32_bf16 v18, v143, v5, v18
    s_waitcnt vmcnt(2)
    buffer_load_dwordx4 v[156:159], v1, s[12:15], s16 offen offset:1024 nt
    v_dot2_f32_bf16 v19, v144, v2, 0
    v_dot2_f32_bf16 v19, v145, v3, v19
    v_dot2_f32_bf16 v19, v146, v4, v19
    v_dot2_f32_bf16 v19, v147, v5, v19
    s_waitcnt vmcnt(2)
    buffer_load_dwordx4 v[160:163], v1, s[12:15], s16 offen offset:2048 nt
    v_dot2_f32_bf16 v20, v148, v2, 0
    v_dot2_f32_bf16 v20, v149, v3, v20
    v_dot2_f32_bf16 v20, v150, v4, v20
    v_dot2_f32_bf16 v20, v151, v5, v20
    s_nop 2
    v_add_f32_dpp v21, v17, v17 row_ror:8 row_mask:0xf bank_mask:0x3
    v_add_f32_dpp v22, v19, v19 row_ror:8 row_mask:0xf bank_mask:0x3
    v_add_f32_dpp v21, v18, v18 row_ror:8 row_mask:0xf bank_mask:0xc
    v_add_f32_dpp v22, v20, v20 row_ror:8 row_mask:0xf bank_mask:0xc
    s_nop 0
    v_add_f32_dpp v23, v21, v21 row_shl:4 row_mask:0xf bank_mask:0x5
    v_add_f32_dpp v23, v22, v22 row_shr:4 row_mask:0xf bank_mask:0xa
    s_nop 1
    v_add_f32_dpp v23, v23, v23 quad_perm:[2,3,0,1] row_mask:0xf bank_mask:0xf
    s_nop 1
    v_add_f32_dpp v23, v23, v23 quad_perm:[1,0,3,2] row_mask:0xf bank_mask:0xf
    v_cvt_pk_bf16_f32 v23, v23, v23
    v_and_b32 v23, 0xffff0000, v23
    v_mul_f32 v23, s18, v23
    v_cvt_pk_bf16_f32 v23, v23, v23
    v_and_b32 v23, 0xffff0000, v23
    v_cmp_gt_f32 vcc, v23, v14
    s_cbranch_vccz L_back_10
    s_call_b64 s[46:47], L_rare
L_back_10:
    v_sub_f32 v21, v23, v14
    v_mul_f32 v21, s19, v21
    v_exp_f32 v21, v21
    s_nop 0
    v_add_f32 v16, v16, v21
    v_cvt_pk_bf16_f32 v24, v21, v21
    s_nop 1
    s_waitcnt vmcnt(2)
    buffer_load_dwordx4 v[164:167], v1, s[12:15], s16 offen offset:3072 nt
    v_and_b32_dpp v26, v24, v6 row_newbcast:0 row_mask:0xf bank_mask:0xf
    v_and_b32_dpp v27, v24, v7 row_newbcast:0 row_mask:0xf bank_mask:0xf
    v_and_b32_dpp v28, v24, v8 row_newbcast:0 row_mask:0xf bank_mask:0xf
    v_and_b32_dpp v29, v24, v9 row_newbcast:0 row_mask:0xf bank_mask:0xf
    s_nop 1
    v_mfma_f32_16x16x32_bf16 v[10:13], v[26:29], v[152:155], v[10:13]
    s_waitcnt vmcnt(2)
    s_add_u32 s16, s44, 1048576
    s_and_b32 s16, s16, 0x1fffff
    s_add_u32 s16, s16, s33
    buffer_load_dwordx4 v[40:43], v1, s[8:11], s16 offen offset:0 nt
    v_and_b32_dpp v30, v24, v6 row_newbcast:8 row_mask:0xf bank_mask:0xf
    v_and_b32_dpp v31, v24, v7 row_newbcast:8 row_mask:0xf bank_mask:0xf
    v_and_b32_dpp v32, v24, v8 row_newbcast:8 row_mask:0xf bank_mask:0xf
    v_and_b32_dpp v33, v24, v9 row_newbcast:8 row_mask:0xf bank_mask:0xf
    s_nop 1
    v_mfma_f32_16x16x32_bf16 v[10:13], v[30:33], v[156:159], v[10:13]
    s_waitcnt vmcnt(2)
    buffer_load_dwordx4 v[44:47], v1, s[8:11], s16 offen offset:1024 nt
    v_and_b32_dpp v26, v24, v6 row_newbcast:4 row_mask:0xf bank_mask:0xf
    v_and_b32_dpp v27, v24, v7 row_newbcast:4 row_mask:0xf bank_mask:0xf
    v_and_b32_dpp v28, v24, v8 row_newbcast:4 row_mask:0xf bank_mask:0xf
    v_and_b32_dpp v29, v24, v9 row_newbcast:4 row_mask:0xf bank_mask:0xf
    s_nop 1
    v_mfma_f32_16x16x32_bf16 v[10:13], v[26:29], v[160:163], v[10:13]
    s_waitcnt vmcnt(2)
    buffer_load_dwordx4 v[48:51], v1, s[8:11], s16 offen offset:2048 nt
    v_and_b32_dpp v30, v24, v6 row_newbcast:12 row_mask:0xf bank_mask:0xf
    v_and_b32_dpp v31, v24, v7 row_newbcast:12 row_mask:0xf bank_mask:0xf
    v_and_b32_dpp v32, v24, v8 row_newbcast:12 row_mask:0xf bank_mask:0xf
    v_and_b32_dpp v33, v24, v9 row_newbcast:12 row_mask:0xf bank_mask:0xf
    s_nop 1
    v_mfma_f32_16x16x32_bf16 v[10:13], v[30:33], v[164:167], v[10:13]
    s_waitcnt vmcnt(2)
    buffer_load_dwordx4 v[52:55], v1, s[8:11], s16 offen offset:3072 nt
    v_dot2_f32_bf16 v17, v40, v2, 0
    v_dot2_f32_bf16 v17, v41, v3, v17
    v_dot2_f32_bf16 v17, v42, v4, v17
    v_dot2_f32_bf16 v17, v43, v5, v17
    s_waitcnt vmcnt(2)
    buffer_load_dwordx4 v[56:59], v1, s[12:15], s16 offen offset:0 nt
    v_dot2_f32_bf16 v18, v44, v2, 0
    v_dot2_f32_bf16 v18, v45, v3, v18
    v_dot2_f32_bf16 v18, v46, v4, v18
    v_dot2_f32_bf16 v18, v47, v5, v18
    s_waitcnt vmcnt(2)
    buffer_load_dwordx4 v[60:63], v1, s[12:15], s16 offen offset:1024 nt
    v_dot2_f32_bf16 v19, v48, v2, 0
    v_dot2_f32_bf16 v19, v49, v3, v19
    v_dot2_f32_bf16 v19, v50, v4, v19
    v_dot2_f32_bf16 v19, v51, v5, v19
    s_waitcnt vmcnt(2)
    buffer_load_dwordx4 v[64:67], v1, s[12:15], s16 offen offset:2048 nt
    v_dot2_f32_bf16 v20, v52, v2, 0
    v_dot2_f32_bf16 v20, v53, v3, v20
    v_dot2_f32_bf16 v20, v54, v4, v20
    v_dot2_f32_bf16 v20, v55, v5, v20
    s_nop 2
    v_add_f32_dpp v21, v17, v17 row_ror:8 row_mask:0xf bank_mask:0x3
    v_add_f32_dpp v22, v19, v19 row_ror:8 row_mask:0xf bank_mask:0x3
    v_add_f32_dpp v21, v18, v18 row_ror:8 row_mask:0xf bank_mask:0xc
    v_add_f32_dpp v22, v20, v20 row_ror:8 row_mask:0xf bank_mask:0xc
    s_nop 0
    v_add_f32_dpp v23, v21, v21 row_shl:4 row_mask:0xf bank_mask:0x5
    v_add_f32_dpp v23, v22, v22 row_shr:4 row_mask:0xf bank_mask:0xa
    s_nop 1
    v_add_f32_dpp v23, v23, v23 quad_perm:[2,3,0,1] row_mask:0xf bank_mask:0xf
    s_nop 1
    v_add_f32_dpp v23, v23, v23 quad_perm:[1,0,3,2] row_mask:0xf bank_mask:0xf
    v_cvt_pk_bf16_f32 v23, v23, v23
    v_and_b32 v23, 0xffff0000, v23
    v_mul_f32 v23, s18, v23
    v_cvt_pk_bf16_f32 v23, v23, v23
    v_and_b32 v23, 0xffff0000, v23
    v_cmp_gt_f32 vcc, v23, v14
    s_cbranch_vccz L_back_11
    s_call_b64 s[46:47], L_rare
L_back_11:
    v_sub_f32 v21, v23, v14
    v_mul_f32 v21, s19, v21
    v_exp_f32 v21, v21
    s_nop 0
    v_add_f32 v16, v16, v21
    v_cvt_pk_bf16_f32 v24, v21, v21
    s_nop 1
    s_waitcnt vmcnt(2)
    buffer_load_dwordx4 v[68:71], v1, s[12:15], s16 offen offset:3072 nt
    v_and_b32_dpp v26, v24, v6 row_newbcast:0 row_mask:0xf bank_mask:0xf
    v_and_b32_dpp v27, v24, v7 row_newbcast:0 row_mask:0xf bank_mask:0xf
    v_and_b32_dpp v28, v24, v8 row_newbcast:0 row_mask:0xf bank_mask:0xf
    v_and_b32_dpp v29, v24, v9 row_newbcast:0 row_mask:0xf bank_mask:0xf
    s_nop 1
    v_mfma_f32_16x16x32_bf16 v[10:13], v[26:29], v[56:59], v[10:13]
    s_waitcnt vmcnt(2)
    s_add_u32 s16, s44, 1179648
    s_and_b32 s16, s16, 0x1fffff
    s_add_u32 s16, s16, s33
    buffer_load_dwordx4 v[72:75], v1, s[8:11], s16 offen offset:0 nt
    v_and_b32_dpp v30, v24, v6 row_newbcast:8 row_mask:0xf bank_mask:0xf
    v_and_b32_dpp v31, v24, v7 row_newbcast:8 row_mask:0xf bank_mask:0xf
    v_and_b32_dpp v32, v24, v8 row_newbcast:8 row_mask:0xf bank_mask:0xf
    v_and_b32_dpp v33, v24, v9 row_newbcast:8 row_mask:0xf bank_mask:0xf
    s_nop 1
    v_mfma_f32_16x16x32_bf16 v[10:13], v[30:33], v[60:63], v[10:13]
    s_waitcnt vmcnt(2)
    buffer_load_dwordx4 v[76:79], v1, s[8:11], s16 offen offset:1024 nt
    v_and_b32_dpp v26, v24, v6 row_newbcast:4 row_mask:0xf bank_mask:0xf
    v_and_b32_dpp v27, v24, v7 row_newbcast:4 row_mask:0xf bank_mask:0xf
    v_and_b32_dpp v28, v24, v8 row_newbcast:4 row_mask:0xf bank_mask:0xf
    v_and_b32_dpp v29, v24, v9 row_newbcast:4 row_mask:0xf bank_mask:0xf
    s_nop 1
    v_mfma_f32_16x16x32_bf16 v[10:13], v[26:29], v[64:67], v[10:13]
    s_waitcnt vmcnt(2)
    buffer_load_dwordx4 v[80:83], v1, s[8:11], s16 offen offset:2048 nt
    v_and_b32_dpp v30, v24, v6 row_newbcast:12 row_mask:0xf bank_mask:0xf
    v_and_b32_dpp v31, v24, v7 row_newbcast:12 row_mask:0xf bank_mask:0xf
    v_and_b32_dpp v32, v24, v8 row_newbcast:12 row_mask:0xf bank_mask:0xf
    v_and_b32_dpp v33, v24, v9 row_newbcast:12 row_mask:0xf bank_mask:0xf
    s_nop 1
    v_mfma_f32_16x16x32_bf16 v[10:13], v[30:33], v[68:71], v[10:13]
    s_waitcnt vmcnt(2)
    buffer_load_dwordx4 v[84:87], v1, s[8:11], s16 offen offset:3072 nt
    v_dot2_f32_bf16 v17, v72, v2, 0
    v_dot2_f32_bf16 v17, v73, v3, v17
    v_dot2_f32_bf16 v17, v74, v4, v17
    v_dot2_f32_bf16 v17, v75, v5, v17
    s_waitcnt vmcnt(2)
    buffer_load_dwordx4 v[88:91], v1, s[12:15], s16 offen offset:0 nt
    v_dot2_f32_bf16 v18, v76, v2, 0
    v_dot2_f32_bf16 v18, v77, v3, v18
    v_dot2_f32_bf16 v18, v78, v4, v18
    v_dot2_f32_bf16 v18, v79, v5, v18
    s_waitcnt vmcnt(2)
    buffer_load_dwordx4 v[92:95], v1, s[12:15], s16 offen offset:1024 nt
    v_dot2_f32_bf16 v19, v80, v2, 0
    v_dot2_f32_bf16 v19, v81, v3, v19
    v_dot2_f32_bf16 v19, v82, v4, v19
    v_dot2_f32_bf16 v19, v83, v5, v19
    s_waitcnt vmcnt(2)
    buffer_load_dwordx4 v[96:99], v1, s[12:15], s16 offen offset:2048 nt
    v_dot2_f32_bf16 v20, v84, v2, 0
    v_dot2_f32_bf16 v20, v85, v3, v20
    v_dot2_f32_bf16 v20, v86, v4, v20
    v_dot2_f32_bf16 v20, v87, v5, v20
    s_nop 2
    v_add_f32_dpp v21, v17, v17 row_ror:8 row_mask:0xf bank_mask:0x3
    v_add_f32_dpp v22, v19, v19 row_ror:8 row_mask:0xf bank_mask:0x3
    v_add_f32_dpp v21, v18, v18 row_ror:8 row_mask:0xf bank_mask:0xc
    v_add_f32_dpp v22, v20, v20 row_ror:8 row_mask:0xf bank_mask:0xc
    s_nop 0
    v_add_f32_dpp v23, v21, v21 row_shl:4 row_mask:0xf bank_mask:0x5
    v_add_f32_dpp v23, v22, v22 row_shr:4 row_mask:0xf bank_mask:0xa
    s_nop 1
    v_add_f32_dpp v23, v23, v23 quad_perm:[2,3,0,1] row_mask:0xf bank_mask:0xf
    s_nop 1
    v_add_f32_dpp v23, v23, v23 quad_perm:[1,0,3,2] row_mask:0xf bank_mask:0xf
    v_cvt_pk_bf16_f32 v23, v23, v23
    v_and_b32 v23, 0xffff0000, v23
    v_mul_f32 v23, s18, v23
    v_cvt_pk_bf16_f32 v23, v23, v23
    v_and_b32 v23, 0xffff0000, v23
    v_cmp_gt_f32 vcc, v23, v14
    s_cbranch_vccz L_back_12
    s_call_b64 s[46:47], L_rare
L_back_12:
    v_sub_f32 v21, v23, v14
    v_mul_f32 v21, s19, v21
    v_exp_f32 v21, v21
    s_nop 0
    v_add_f32 v16, v16, v21
    v_cvt_pk_bf16_f32 v24, v21, v21
    s_nop 1
    s_waitcnt vmcnt(2)
    buffer_load_dwordx4 v[100:103], v1, s[12:15], s16 offen offset:3072 nt
    v_and_b32_dpp v26, v24, v6 row_newbcast:0 row_mask:0xf bank_mask:0xf
    v_and_b32_dpp v27, v24, v7 row_newbcast:0 row_mask:0xf bank_mask:0xf
    v_and_b32_dpp v28, v24, v8 row_newbcast:0 row_mask:0xf bank_mask:0xf
    v_and_b32_dpp v29, v24, v9 row_newbcast:0 row_mask:0xf bank_mask:0xf
    s_nop 1
    v_mfma_f32_16x16x32_bf16 v[10:13], v[26:29], v[88:91], v[10:13]
    s_waitcnt vmcnt(2)
    s_add_u32 s16, s44, 1310720
    s_and_b32 s16, s16, 0x1fffff
    s_add_u32 s16, s16, s33
    buffer_load_dwordx4 v[104:107], v1, s[8:11], s16 offen offset:0 nt
    v_and_b32_dpp v30, v24, v6 row_newbcast:8 row_mask:0xf bank_mask:0xf
    v_and_b32_dpp v31, v24, v7 row_newbcast:8 row_mask:0xf bank_mask:0xf
    v_and_b32_dpp v32, v24, v8 row_newbcast:8 row_mask:0xf bank_mask:0xf
    v_and_b32_dpp v33, v24, v9 row_newbcast:8 row_mask:0xf bank_mask:0xf
    s_nop 1
    v_mfma_f32_16x16x32_bf16 v[10:13], v[30:33], v[92:95], v[10:13]
    s_waitcnt vmcnt(2)
    buffer_load_dwordx4 v[108:111], v1, s[8:11], s16 offen offset:1024 nt
    v_and_b32_dpp v26, v24, v6 row_newbcast:4 row_mask:0xf bank_mask:0xf
    v_and_b32_dpp v27, v24, v7 row_newbcast:4 row_mask:0xf bank_mask:0xf
    v_and_b32_dpp v28, v24, v8 row_newbcast:4 row_mask:0xf bank_mask:0xf
    v_and_b32_dpp v29, v24, v9 row_newbcast:4 row_mask:0xf bank_mask:0xf
    s_nop 1
    v_mfma_f32_16x16x32_bf16 v[10:13], v[26:29], v[96:99], v[10:13]
    s_waitcnt vmcnt(2)
    buffer_load_dwordx4 v[112:115], v1, s[8:11], s16 offen offset:2048 nt
    v_and_b32_dpp v30, v24, v6 row_newbcast:12 row_mask:0xf bank_mask:0xf
    v_and_b32_dpp v31, v24, v7 row_newbcast:12 row_mask:0xf bank_mask:0xf
    v_and_b32_dpp v32, v24, v8 row_newbcast:12 row_mask:0xf bank_mask:0xf
    v_and_b32_dpp v33, v24, v9 row_newbcast:12 row_mask:0xf bank_mask:0xf
    s_nop 1
    v_mfma_f32_16x16x32_bf16 v[10:13], v[30:33], v[100:103], v[10:13]
    s_waitcnt vmcnt(2)
    buffer_load_dwordx4 v[116:119], v1, s[8:11], s16 offen offset:3072 nt
    v_dot2_f32_bf16 v17, v104, v2, 0
    v_dot2_f32_bf16 v17, v105, v3, v17
    v_dot2_f32_bf16 v17, v106, v4, v17
    v_dot2_f32_bf16 v17, v107, v5, v17
    s_waitcnt vmcnt(2)
    buffer_load_dwordx4 v[120:123], v1, s[12:15], s16 offen offset:0 nt
    v_dot2_f32_bf16 v18, v108, v2, 0
    v_dot2_f32_bf16 v18, v109, v3, v18
    v_dot2_f32_bf16 v18, v110, v4, v18
    v_dot2_f32_bf16 v18, v111, v5, v18
    s_waitcnt vmcnt(2)
    buffer_load_dwordx4 v[124:127], v1, s[12:15], s16 offen offset:1024 nt
    v_dot2_f32_bf16 v19, v112, v2, 0
    v_dot2_f32_bf16 v19, v113, v3, v19
    v_dot2_f32_bf16 v19, v114, v4, v19
    v_dot2_f32_bf16 v19, v115, v5, v19
    s_waitcnt vmcnt(2)
    buffer_load_dwordx4 v[128:131], v1, s[12:15], s16 offen offset:2048 nt
    v_dot2_f32_bf16 v20, v116, v2, 0
    v_dot2_f32_bf16 v20, v117, v3, v20
    v_dot2_f32_bf16 v20, v118, v4, v20
    v_dot2_f32_bf16 v20, v119, v5, v20
    s_nop 2
    v_add_f32_dpp v21, v17, v17 row_ror:8 row_mask:0xf bank_mask:0x3
    v_add_f32_dpp v22, v19, v19 row_ror:8 row_mask:0xf bank_mask:0x3
    v_add_f32_dpp v21, v18, v18 row_ror:8 row_mask:0xf bank_mask:0xc
    v_add_f32_dpp v22, v20, v20 row_ror:8 row_mask:0xf bank_mask:0xc
    s_nop 0
    v_add_f32_dpp v23, v21, v21 row_shl:4 row_mask:0xf bank_mask:0x5
    v_add_f32_dpp v23, v22, v22 row_shr:4 row_mask:0xf bank_mask:0xa
    s_nop 1
    v_add_f32_dpp v23, v23, v23 quad_perm:[2,3,0,1] row_mask:0xf bank_mask:0xf
    s_nop 1
    v_add_f32_dpp v23, v23, v23 quad_perm:[1,0,3,2] row_mask:0xf bank_mask:0xf
    v_cvt_pk_bf16_f32 v23, v23, v23
    v_and_b32 v23, 0xffff0000, v23
    v_mul_f32 v23, s18, v23
    v_cvt_pk_bf16_f32 v23, v23, v23
    v_and_b32 v23, 0xffff0000, v23
    v_cmp_gt_f32 vcc, v23, v14
    s_cbranch_vccz L_back_13
    s_call_b64 s[46:47], L_rare
L_back_13:
    v_sub_f32 v21, v23, v14
    v_mul_f32 v21, s19, v21
    v_exp_f32 v21, v21
    s_nop 0
    v_add_f32 v16, v16, v21
    v_cvt_pk_bf16_f32 v24, v21, v21
    s_nop 1
    s_waitcnt vmcnt(2)
    buffer_load_dwordx4 v[132:135], v1, s[12:15], s16 offen offset:3072 nt
    v_and_b32_dpp v26, v24, v6 row_newbcast:0 row_mask:0xf bank_mask:0xf
    v_and_b32_dpp v27, v24, v7 row_newbcast:0 row_mask:0xf bank_mask:0xf
    v_and_b32_dpp v28, v24, v8 row_newbcast:0 row_mask:0xf bank_mask:0xf
    v_and_b32_dpp v29, v24, v9 row_newbcast:0 row_mask:0xf bank_mask:0xf
    s_nop 1
    v_mfma_f32_16x16x32_bf16 v[10:13], v[26:29], v[120:123], v[10:13]
    s_waitcnt vmcnt(2)
    s_add_u32 s16, s44, 1441792
    s_and_b32 s16, s16, 0x1fffff
    s_add_u32 s16, s16, s33
    buffer_load_dwordx4 v[136:139], v1, s[8:11], s16 offen offset:0 nt
    v_and_b32_dpp v30, v24, v6 row_newbcast:8 row_mask:0xf bank_mask:0xf
    v_and_b32_dpp v31, v24, v7 row_newbcast:8 row_mask:0xf bank_mask:0xf
    v_and_b32_dpp v32, v24, v8 row_newbcast:8 row_mask:0xf bank_mask:0xf
    v_and_b32_dpp v33, v24, v9 row_newbcast:8 row_mask:0xf bank_mask:0xf
    s_nop 1
    v_mfma_f32_16x16x32_bf16 v[10:13], v[30:33], v[124:127], v[10:13]
    s_waitcnt vmcnt(2)
    buffer_load_dwordx4 v[140:143], v1, s[8:11], s16 offen offset:1024 nt
    v_and_b32_dpp v26, v24, v6 row_newbcast:4 row_mask:0xf bank_mask:0xf
    v_and_b32_dpp v27, v24, v7 row_newbcast:4 row_mask:0xf bank_mask:0xf
    v_and_b32_dpp v28, v24, v8 row_newbcast:4 row_mask:0xf bank_mask:0xf
    v_and_b32_dpp v29, v24, v9 row_newbcast:4 row_mask:0xf bank_mask:0xf
    s_nop 1
    v_mfma_f32_16x16x32_bf16 v[10:13], v[26:29], v[128:131], v[10:13]
    s_waitcnt vmcnt(2)
    buffer_load_dwordx4 v[144:147], v1, s[8:11], s16 offen offset:2048 nt
    v_and_b32_dpp v30, v24, v6 row_newbcast:12 row_mask:0xf bank_mask:0xf
    v_and_b32_dpp v31, v24, v7 row_newbcast:12 row_mask:0xf bank_mask:0xf
    v_and_b32_dpp v32, v24, v8 row_newbcast:12 row_mask:0xf bank_mask:0xf
    v_and_b32_dpp v33, v24, v9 row_newbcast:12 row_mask:0xf bank_mask:0xf
    s_nop 1
    v_mfma_f32_16x16x32_bf16 v[10:13], v[30:33], v[132:135], v[10:13]
    v_mov_b32 v84, 0
    v_mov_b32 v87, 0
    v_mov_b32 v86, 1
    s_sub_u32 s42, s42, 0x8000
    s_add_u32 s42, s42, s43
L_dyn:
    ds_max_u32 v87, v86 offset:4704
    s_waitcnt vmcnt(2)
    buffer_load_dwordx4 v[148:151], v1, s[8:11], s16 offen offset:3072 nt
    v_dot2_f32_bf16 v17, v136, v2, 0
    v_dot2_f32_bf16 v17, v137, v3, v17
    v_dot2_f32_bf16 v17, v138, v4, v17
    v_dot2_f32_bf16 v17, v139, v5, v17
    s_waitcnt vmcnt(2)
    buffer_load_dwordx4 v[152:155], v1, s[12:15], s16 offen offset:0 nt
    v_dot2_f32_bf16 v18, v140, v2, 0
    v_dot2_f32_bf16 v18, v141, v3, v18
    v_dot2_f32_bf16 v18, v142, v4, v18
    v_dot2_f32_bf16 v18, v143, v5, v18
    s_waitcnt vmcnt(2)
    buffer_load_dwordx4 v[156:159], v1, s[12:15], s16 offen offset:1024 nt
    v_dot2_f32_bf16 v19, v144, v2, 0
    v_dot2_f32_bf16 v19, v145, v3, v19
    v_dot2_f32_bf16 v19, v146, v4, v19
    v_dot2_f32_bf16 v19, v147, v5, v19
    s_waitcnt vmcnt(2)
    buffer_load_dwordx4 v[160:163], v1, s[12:15], s16 offen offset:2048 nt
    v_dot2_f32_bf16 v20, v148, v2, 0
    v_dot2_f32_bf16 v20, v149, v3, v20
    v_dot2_f32_bf16 v20, v150, v4, v20
    v_dot2_f32_bf16 v20, v151, v5, v20
    s_nop 2
    v_add_f32_dpp v21, v17, v17 row_ror:8 row_mask:0xf bank_mask:0x3
    v_add_f32_dpp v22, v19, v19 row_ror:8 row_mask:0xf bank_mask:0x3
    v_add_f32_dpp v21, v18, v18 row_ror:8 row_mask:0xf bank_mask:0xc
    v_add_f32_dpp v22, v20, v20 row_ror:8 row_mask:0xf bank_mask:0xc
    s_nop 0
    v_add_f32_dpp v23, v21, v21 row_shl:4 row_mask:0xf bank_mask:0x5
    v_add_f32_dpp v23, v22, v22 row_shr:4 row_mask:0xf bank_mask:0xa
    s_nop 1
    v_add_f32_dpp v23, v23, v23 quad_perm:[2,3,0,1] row_mask:0xf bank_mask:0xf
    s_nop 1
    v_add_f32_dpp v23, v23, v23 quad_perm:[1,0,3,2] row_mask:0xf bank_mask:0xf
    v_cvt_pk_bf16_f32 v23, v23, v23
    v_and_b32 v23, 0xffff0000, v23
    v_mul_f32 v23, s18, v23
    v_cvt_pk_bf16_f32 v23, v23, v23
    v_and_b32 v23, 0xffff0000, v23
    v_cmp_gt_f32 vcc, v23, v14
    s_cbranch_vccz L_back_14
    s_call_b64 s[46:47], L_rare
L_back_14:
    v_sub_f32 v21, v23, v14
    v_mul_f32 v21, s19, v21
    v_exp_f32 v21, v21
    s_nop 0
    v_add_f32 v16, v16, v21
    v_cvt_pk_bf16_f32 v24, v21, v21
    s_nop 1
    ds_read_b32 v85, v84 offset:4928
    s_waitcnt vmcnt(2)
    buffer_load_dwordx4 v[164:167], v1, s[12:15], s16 offen offset:3072 nt
    v_and_b32_dpp v26, v24, v6 row_newbcast:0 row_mask:0xf bank_mask:0xf
    v_and_b32_dpp v27, v24, v7 row_newbcast:0 row_mask:0xf bank_mask:0xf
    v_and_b32_dpp v28, v24, v8 row_newbcast:0 row_mask:0xf bank_mask:0xf
    v_and_b32_dpp v29, v24, v9 row_newbcast:0 row_mask:0xf bank_mask:0xf
    s_nop 1
    v_mfma_f32_16x16x32_bf16 v[10:13], v[26:29], v[152:155], v[10:13]
    s_waitcnt lgkmcnt(0)
    v_readfirstlane_b32 s24, v85
    s_cmp_lg_u32 s24, 0
    s_cbranch_scc1 L_got_15
    s_call_b64 s[46:47], L_rlspin
L_got_15:
    s_cmp_ge_u32 s24, 61
    s_cbranch_scc1 L_fin
    v_add_u32 v86, 1, v86
    v_add_u32 v84, 4, v84
    s_lshl_b32 s16, s24, 15
    s_add_u32 s16, s16, s42
    s_waitcnt vmcnt(2)
    buffer_load_dwordx4 v[136:139], v1, s[8:11], s16 offen offset:0 nt
    v_and_b32_dpp v30, v24, v6 row_newbcast:8 row_mask:0xf bank_mask:0xf
    v_and_b32_dpp v31, v24, v7 row_newbcast:8 row_mask:0xf bank_mask:0xf
    v_and_b32_dpp v32, v24, v8 row_newbcast:8 row_mask:0xf bank_mask:0xf
    v_and_b32_dpp v33, v24, v9 row_newbcast:8 row_mask:0xf bank_mask:0xf
    s_nop 1
    v_mfma_f32_16x16x32_bf16 v[10:13], v[30:33], v[156:159], v[10:13]
    s_waitcnt vmcnt(2)
    buffer_load_dwordx4 v[140:143], v1, s[8:11], s16 offen offset:1024 nt
    v_and_b32_dpp v26, v24, v6 row_newbcast:4 row_mask:0xf bank_mask:0xf
    v_and_b32_dpp v27, v24, v7 row_newbcast:4 row_mask:0xf bank_mask:0xf
    v_and_b32_dpp v28, v24, v8 row_newbcast:4 row_mask:0xf bank_mask:0xf
    v_and_b32_dpp v29, v24, v9 row_newbcast:4 row_mask:0xf bank_mask:0xf
    s_nop 1
    v_mfma_f32_16x16x32_bf16 v[10:13], v[26:29], v[160:163], v[10:13]
    s_waitcnt vmcnt(2)
    buffer_load_dwordx4 v[144:147], v1, s[8:11], s16 offen offset:2048 nt
    v_and_b32_dpp v30, v24, v6 row_newbcast:12 row_mask:0xf bank_mask:0xf
    v_and_b32_dpp v31, v24, v7 row_newbcast:12 row_mask:0xf bank_mask:0xf
    v_and_b32_dpp v32, v24, v8 row_newbcast:12 row_mask:0xf bank_mask:0xf
    v_and_b32_dpp v33, v24, v9 row_newbcast:12 row_mask:0xf bank_mask:0xf
    s_nop 1
    v_mfma_f32_16x16x32_bf16 v[10:13], v[30:33], v[164:167], v[10:13]
    s_branch L_dyn
L_rlspin:
L_poll_16:
    ds_read_b32 v85, v84 offset:4928
    s_waitcnt lgkmcnt(0)
    v_cmp_eq_u32 vcc, 0, v85
    s_cbranch_vccz L_pdone_17
    s_cmp_eq_u32 s88, 0
    s_cbranch_scc1 L_pdone_17
    s_sub_u32 s88, s88, 1
    s_sleep 1
    s_branch L_poll_16
L_pdone_17:
    v_readfirstlane_b32 s24, v85
    s_cmp_eq_u32 s24, 0
    s_cselect_b32 s24, 65, s24
    s_setpc_b64 s[46:47]
L_fin:
    s_cmp_ge_u32 s24, 65
    s_cbranch_scc1 L_fin_last
    v_add_u32 v86, 1, v86
    v_add_u32 v84, 4, v84
    ds_max_u32 v87, v86 offset:4704
    s_lshl_b32 s25, s24, 15
    s_add_u32 s25, s25, s42
    buffer_load_dwordx4 v[40:43], v1, s[8:11], s25 offen offset:0 nt
    buffer_load_dwordx4 v[44:47], v1, s[8:11], s25 offen offset:1024 nt
    buffer_load_dwordx4 v[48:51], v1, s[8:11], s25 offen offset:2048 nt
    buffer_load_dwordx4 v[52:55], v1, s[8:11], s25 offen offset:3072 nt
    buffer_load_dwordx4 v[56:59], v1, s[12:15], s25 offen offset:0 nt
    buffer_load_dwordx4 v[60:63], v1, s[12:15], s25 offen offset:1024 nt
    buffer_load_dwordx4 v[64:67], v1, s[12:15], s25 offen offset:2048 nt
    buffer_load_dwordx4 v[68:71], v1, s[12:15], s25 offen offset:3072 nt
    s_waitcnt vmcnt(10)
    v_and_b32_dpp v30, v24, v6 row_newbcast:8 row_mask:0xf bank_mask:0xf
    v_and_b32_dpp v31, v24, v7 row_newbcast:8 row_mask:0xf bank_mask:0xf
    v_and_b32_dpp v32, v24, v8 row_newbcast:8 row_mask:0xf bank_mask:0xf
    v_and_b32_dpp v33, v24, v9 row_newbcast:8 row_mask:0xf bank_mask:0xf
    s_nop 1
    v_mfma_f32_16x16x32_bf16 v[10:13], v[30:33], v[156:159], v[10:13]
    s_waitcnt vmcnt(9)
    v_and_b32_dpp v26, v24, v6 row_newbcast:4 row_mask:0xf bank_mask:0xf
    v_and_b32_dpp v27, v24, v7 row_newbcast:4 row_mask:0xf bank_mask:0xf
    v_and_b32_dpp v28, v24, v8 row_newbcast:4 row_mask:0xf bank_mask:0xf
    v_and_b32_dpp v29, v24, v9 row_newbcast:4 row_mask:0xf bank_mask:0xf
    s_nop 1
    v_mfma_f32_16x16x32_bf16 v[10:13], v[26:29], v[160:163], v[10:13]
    s_waitcnt vmcnt(8)
    v_and_b32_dpp v30, v24, v6 row_newbcast:12 row_mask:0xf bank_mask:0xf
    v_and_b32_dpp v31, v24, v7 row_newbcast:12 row_mask:0xf bank_mask:0xf
    v_and_b32_dpp v32, v24, v8 row_newbcast:12 row_mask:0xf bank_mask:0xf
    v_and_b32_dpp v33, v24, v9 row_newbcast:12 row_mask:0xf bank_mask:0xf
    s_nop 1
    v_mfma_f32_16x16x32_bf16 v[10:13], v[30:33], v[164:167], v[10:13]
L_egA:
    ds_read_b32 v85, v84 offset:4928
    s_waitcnt lgkmcnt(0)
    v_readfirstlane_b32 s24, v85
    s_cmp_lg_u32 s24, 0
    s_cbranch_scc1 L_got_18
    s_call_b64 s[46:47], L_rlspin
L_got_18:
    s_cmp_ge_u32 s24, 65
    s_cbranch_scc1 L_drainA
    v_add_u32 v86, 1, v86
    v_add_u32 v84, 4, v84
    ds_max_u32 v87, v86 offset:4704
    s_lshl_b32 s25, s24, 15
    s_add_u32 s25, s25, s42
    buffer_load_dwordx4 v[136:139], v1, s[8:11], s25 offen offset:0 nt
    buffer_load_dwordx4 v[140:143], v1, s[8:11], s25 offen offset:1024 nt
    buffer_load_dwordx4 v[144:147], v1, s[8:11], s25 offen offset:2048 nt
    buffer_load_dwordx4 v[148:151], v1, s[8:11], s25 offen offset:3072 nt
    buffer_load_dwordx4 v[152:155], v1, s[12:15], s25 offen offset:0 nt
    buffer_load_dwordx4 v[156:159], v1, s[12:15], s25 offen offset:1024 nt
    buffer_load_dwordx4 v[160:163], v1, s[12:15], s25 offen offset:2048 nt
    buffer_load_dwordx4 v[164:167], v1, s[12:15], s25 offen offset:3072 nt
    s_waitcnt vmcnt(15)
    v_dot2_f32_bf16 v17, v40, v2, 0
    v_dot2_f32_bf16 v17, v41, v3, v17
    v_dot2_f32_bf16 v17, v42, v4, v17
    v_dot2_f32_bf16 v17, v43, v5, v17
    s_waitcnt vmcnt(14)
    v_dot2_f32_bf16 v18, v44, v2, 0
    v_dot2_f32_bf16 v18, v45, v3, v18
    v_dot2_f32_bf16 v18, v46, v4, v18
    v_dot2_f32_bf16 v18, v47, v5, v18
    s_waitcnt vmcnt(13)
    v_dot2_f32_bf16 v19, v48, v2, 0
    v_dot2_f32_bf16 v19, v49, v3, v19
    v_dot2_f32_bf16 v19, v50, v4, v19
    v_dot2_f32_bf16 v19, v51, v5, v19
    s_waitcnt vmcnt(12)
    v_dot2_f32_bf16 v20, v52, v2, 0
    v_dot2_f32_bf16 v20, v53, v3, v20
    v_dot2_f32_bf16 v20, v54, v4, v20
    v_dot2_f32_bf16 v20, v55, v5, v20
    s_nop 2
    v_add_f32_dpp v21, v17, v17 row_ror:8 row_mask:0xf bank_mask:0x3
    v_add_f32_dpp v22, v19, v19 row_ror:8 row_mask:0xf bank_mask:0x3
    v_add_f32_dpp v21, v18, v18 row_ror:8 row_mask:0xf bank_mask:0xc
    v_add_f32_dpp v22, v20, v20 row_ror:8 row_mask:0xf bank_mask:0xc
    s_nop 0
    v_add_f32_dpp v23, v21, v21 row_shl:4 row_mask:0xf bank_mask:0x5
    v_add_f32_dpp v23, v22, v22 row_shr:4 row_mask:0xf bank_mask:0xa
    s_nop 1
    v_add_f32_dpp v23, v23, v23 quad_perm:[2,3,0,1] row_mask:0xf bank_mask:0xf
    s_nop 1
    v_add_f32_dpp v23, v23, v23 quad_perm:[1,0,3,2] row_mask:0xf bank_mask:0xf
    v_cvt_pk_bf16_f32 v23, v23, v23
    v_and_b32 v23, 0xffff0000, v23
    v_mul_f32 v23, s18, v23
    v_cvt_pk_bf16_f32 v23, v23, v23
    v_and_b32 v23, 0xffff0000, v23
    v_cmp_gt_f32 vcc, v23, v14
    s_cbranch_vccz L_back_19
    s_call_b64 s[46:47], L_rare
L_back_19:
    v_sub_f32 v21, v23, v14
    v_mul_f32 v21, s19, v21
    v_exp_f32 v21, v21
    s_nop 0
    v_add_f32 v16, v16, v21
    v_cvt_pk_bf16_f32 v24, v21, v21
    s_nop 1
    s_waitcnt vmcnt(11)
    v_and_b32_dpp v26, v24, v6 row_newbcast:0 row_mask:0xf bank_mask:0xf
    v_and_b32_dpp v27, v24, v7 row_newbcast:0 row_mask:0xf bank_mask:0xf
    v_and_b32_dpp v28, v24, v8 row_newbcast:0 row_mask:0xf bank_mask:0xf
    v_and_b32_dpp v29, v24, v9 row_newbcast:0 row_mask:0xf bank_mask:0xf
    s_nop 1
    v_mfma_f32_16x16x32_bf16 v[10:13], v[26:29], v[56:59], v[10:13]
    s_waitcnt vmcnt(10)
    v_and_b32_dpp v30, v24, v6 row_newbcast:8 row_mask:0xf bank_mask:0xf
    v_and_b32_dpp v31, v24, v7 row_newbcast:8 row_mask:0xf bank_mask:0xf
    v_and_b32_dpp v32, v24, v8 row_newbcast:8 row_mask:0xf bank_mask:0xf
    v_and_b32_dpp v33, v24, v9 row_newbcast:8 row_mask:0xf bank_mask:0xf
    s_nop 1
    v_mfma_f32_16x16x32_bf16 v[10:13], v[30:33], v[60:63], v[10:13]
    s_waitcnt vmcnt(9)
    v_and_b32_dpp v26, v24, v6 row_newbcast:4 row_mask:0xf bank_mask:0xf
    v_and_b32_dpp v27, v24, v7 row_newbcast:4 row_mask:0xf bank_mask:0xf
    v_and_b32_dpp v28, v24, v8 row_newbcast:4 row_mask:0xf bank_mask:0xf
    v_and_b32_dpp v29, v24, v9 row_newbcast:4 row_mask:0xf bank_mask:0xf
    s_nop 1
    v_mfma_f32_16x16x32_bf16 v[10:13], v[26:29], v[64:67], v[10:13]
    s_waitcnt vmcnt(8)
    v_and_b32_dpp v30, v24, v6 row_newbcast:12 row_mask:0xf bank_mask:0xf
    v_and_b32_dpp v31, v24, v7 row_newbcast:12 row_mask:0xf bank_mask:0xf
    v_and_b32_dpp v32, v24, v8 row_newbcast:12 row_mask:0xf bank_mask:0xf
    v_and_b32_dpp v33, v24, v9 row_newbcast:12 row_mask:0xf bank_mask:0xf
    s_nop 1
    v_mfma_f32_16x16x32_bf16 v[10:13], v[30:33], v[68:71], v[10:13]
L_egB:
    ds_read_b32 v85, v84 offset:4928
    s_waitcnt lgkmcnt(0)
    v_readfirstlane_b32 s24, v85
    s_cmp_lg_u32 s24, 0
    s_cbranch_scc1 L_got_20
    s_call_b64 s[46:47], L_rlspin
L_got_20:
    s_cmp_ge_u32 s24, 65
    s_cbranch_scc1 L_drainB
    v_add_u32 v86, 1, v86
    v_add_u32 v84, 4, v84
    ds_max_u32 v87, v86 offset:4704
    s_lshl_b32 s25, s24, 15
    s_add_u32 s25, s25, s42
    buffer_load_dwordx4 v[40:43], v1, s[8:11], s25 offen offset:0 nt
    buffer_load_dwordx4 v[44:47], v1, s[8:11], s25 offen offset:1024 nt
    buffer_load_dwordx4 v[48:51], v1, s[8:11], s25 offen offset:2048 nt
    buffer_load_dwordx4 v[52:55], v1, s[8:11], s25 offen offset:3072 nt
    buffer_load_dwordx4 v[56:59], v1, s[12:15], s25 offen offset:0 nt
    buffer_load_dwordx4 v[60:63], v1, s[12:15], s25 offen offset:1024 nt
    buffer_load_dwordx4 v[64:67], v1, s[12:15], s25 offen offset:2048 nt
    buffer_load_dwordx4 v[68:71], v1, s[12:15], s25 offen offset:3072 nt
    s_waitcnt vmcnt(15)
    v_dot2_f32_bf16 v17, v136, v2, 0
    v_dot2_f32_bf16 v17, v137, v3, v17
    v_dot2_f32_bf16 v17, v138, v4, v17
    v_dot2_f32_bf16 v17, v139, v5, v17
    s_waitcnt vmcnt(14)
    v_dot2_f32_bf16 v18, v140, v2, 0
    v_dot2_f32_bf16 v18, v141, v3, v18
    v_dot2_f32_bf16 v18, v142, v4, v18
    v_dot2_f32_bf16 v18, v143, v5, v18
    s_waitcnt vmcnt(13)
    v_dot2_f32_bf16 v19, v144, v2, 0
    v_dot2_f32_bf16 v19, v145, v3, v19
    v_dot2_f32_bf16 v19, v146, v4, v19
    v_dot2_f32_bf16 v19, v147, v5, v19
    s_waitcnt vmcnt(12)
    v_dot2_f32_bf16 v20, v148, v2, 0
    v_dot2_f32_bf16 v20, v149, v3, v20
    v_dot2_f32_bf16 v20, v150, v4, v20
    v_dot2_f32_bf16 v20, v151, v5, v20
    s_nop 2
    v_add_f32_dpp v21, v17, v17 row_ror:8 row_mask:0xf bank_mask:0x3
    v_add_f32_dpp v22, v19, v19 row_ror:8 row_mask:0xf bank_mask:0x3
    v_add_f32_dpp v21, v18, v18 row_ror:8 row_mask:0xf bank_mask:0xc
    v_add_f32_dpp v22, v20, v20 row_ror:8 row_mask:0xf bank_mask:0xc
    s_nop 0
    v_add_f32_dpp v23, v21, v21 row_shl:4 row_mask:0xf bank_mask:0x5
    v_add_f32_dpp v23, v22, v22 row_shr:4 row_mask:0xf bank_mask:0xa
    s_nop 1
    v_add_f32_dpp v23, v23, v23 quad_perm:[2,3,0,1] row_mask:0xf bank_mask:0xf
    s_nop 1
    v_add_f32_dpp v23, v23, v23 quad_perm:[1,0,3,2] row_mask:0xf bank_mask:0xf
    v_cvt_pk_bf16_f32 v23, v23, v23
    v_and_b32 v23, 0xffff0000, v23
    v_mul_f32 v23, s18, v23
    v_cvt_pk_bf16_f32 v23, v23, v23
    v_and_b32 v23, 0xffff0000, v23
    v_cmp_gt_f32 vcc, v23, v14
    s_cbranch_vccz L_back_21
    s_call_b64 s[46:47], L_rare
L_back_21:
    v_sub_f32 v21, v23, v14
    v_mul_f32 v21, s19, v21
    v_exp_f32 v21, v21
    s_nop 0
    v_add_f32 v16, v16, v21
    v_cvt_pk_bf16_f32 v24, v21, v21
    s_nop 1
    s_waitcnt vmcnt(11)
    v_and_b32_dpp v26, v24, v6 row_newbcast:0 row_mask:0xf bank_mask:0xf
    v_and_b32_dpp v27, v24, v7 row_newbcast:0 row_mask:0xf bank_mask:0xf
    v_and_b32_dpp v28, v24, v8 row_newbcast:0 row_mask:0xf bank_mask:0xf
    v_and_b32_dpp v29, v24, v9 row_newbcast:0 row_mask:0xf bank_mask:0xf
    s_nop 1
    v_mfma_f32_16x16x32_bf16 v[10:13], v[26:29], v[152:155], v[10:13]
    s_waitcnt vmcnt(10)
    v_and_b32_dpp v30, v24, v6 row_newbcast:8 row_mask:0xf bank_mask:0xf
    v_and_b32_dpp v31, v24, v7 row_newbcast:8 row_mask:0xf bank_mask:0xf
    v_and_b32_dpp v32, v24, v8 row_newbcast:8 row_mask:0xf bank_mask:0xf
    v_and_b32_dpp v33, v24, v9 row_newbcast:8 row_mask:0xf bank_mask:0xf
    s_nop 1
    v_mfma_f32_16x16x32_bf16 v[10:13], v[30:33], v[156:159], v[10:13]
    s_waitcnt vmcnt(9)
    v_and_b32_dpp v26, v24, v6 row_newbcast:4 row_mask:0xf bank_mask:0xf
    v_and_b32_dpp v27, v24, v7 row_newbcast:4 row_mask:0xf bank_mask:0xf
    v_and_b32_dpp v28, v24, v8 row_newbcast:4 row_mask:0xf bank_mask:0xf
    v_and_b32_dpp v29, v24, v9 row_newbcast:4 row_mask:0xf bank_mask:0xf
    s_nop 1
    v_mfma_f32_16x16x32_bf16 v[10:13], v[26:29], v[160:163], v[10:13]
    s_waitcnt vmcnt(8)
    v_and_b32_dpp v30, v24, v6 row_newbcast:12 row_mask:0xf bank_mask:0xf
    v_and_b32_dpp v31, v24, v7 row_newbcast:12 row_mask:0xf bank_mask:0xf
    v_and_b32_dpp v32, v24, v8 row_newbcast:12 row_mask:0xf bank_mask:0xf
    v_and_b32_dpp v33, v24, v9 row_newbcast:12 row_mask:0xf bank_mask:0xf
    s_nop 1
    v_mfma_f32_16x16x32_bf16 v[10:13], v[30:33], v[164:167], v[10:13]
    s_branch L_egA
L_drainA:
    s_waitcnt vmcnt(7)
    v_dot2_f32_bf16 v17, v40, v2, 0
    v_dot2_f32_bf16 v17, v41, v3, v17
    v_dot2_f32_bf16 v17, v42, v4, v17
    v_dot2_f32_bf16 v17, v43, v5, v17
    s_waitcnt vmcnt(6)
    v_dot2_f32_bf16 v18, v44, v2, 0
    v_dot2_f32_bf16 v18, v45, v3, v18
    v_dot2_f32_bf16 v18, v46, v4, v18
    v_dot2_f32_bf16 v18, v47, v5, v18
    s_waitcnt vmcnt(5)
    v_dot2_f32_bf16 v19, v48, v2, 0
    v_dot2_f32_bf16 v19, v49, v3, v19
    v_dot2_f32_bf16 v19, v50, v4, v19
    v_dot2_f32_bf16 v19, v51, v5, v19
    s_waitcnt vmcnt(4)
    v_dot2_f32_bf16 v20, v52, v2, 0
    v_dot2_f32_bf16 v20, v53, v3, v20
    v_dot2_f32_bf16 v20, v54, v4, v20
    v_dot2_f32_bf16 v20, v55, v5, v20
    s_nop 2
    v_add_f32_dpp v21, v17, v17 row_ror:8 row_mask:0xf bank_mask:0x3
    v_add_f32_dpp v22, v19, v19 row_ror:8 row_mask:0xf bank_mask:0x3
    v_add_f32_dpp v21, v18, v18 row_ror:8 row_mask:0xf bank_mask:0xc
    v_add_f32_dpp v22, v20, v20 row_ror:8 row_mask:0xf bank_mask:0xc
    s_nop 0
    v_add_f32_dpp v23, v21, v21 row_shl:4 row_mask:0xf bank_mask:0x5
    v_add_f32_dpp v23, v22, v22 row_shr:4 row_mask:0xf bank_mask:0xa
    s_nop 1
    v_add_f32_dpp v23, v23, v23 quad_perm:[2,3,0,1] row_mask:0xf bank_mask:0xf
    s_nop 1
    v_add_f32_dpp v23, v23, v23 quad_perm:[1,0,3,2] row_mask:0xf bank_mask:0xf
    v_cvt_pk_bf16_f32 v23, v23, v23
    v_and_b32 v23, 0xffff0000, v23
    v_mul_f32 v23, s18, v23
    v_cvt_pk_bf16_f32 v23, v23, v23
    v_and_b32 v23, 0xffff0000, v23
    v_cmp_gt_f32 vcc, v23, v14
    s_cbranch_vccz L_back_22
    s_call_b64 s[46:47], L_rare
L_back_22:
    v_sub_f32 v21, v23, v14
    v_mul_f32 v21, s19, v21
    v_exp_f32 v21, v21
    s_nop 0
    v_add_f32 v16, v16, v21
    v_cvt_pk_bf16_f32 v24, v21, v21
    s_nop 1
    s_waitcnt vmcnt(3)
    v_and_b32_dpp v26, v24, v6 row_newbcast:0 row_mask:0xf bank_mask:0xf
    v_and_b32_dpp v27, v24, v7 row_newbcast:0 row_mask:0xf bank_mask:0xf
    v_and_b32_dpp v28, v24, v8 row_newbcast:0 row_mask:0xf bank_mask:0xf
    v_and_b32_dpp v29, v24, v9 row_newbcast:0 row_mask:0xf bank_mask:0xf
    s_nop 1
    v_mfma_f32_16x16x32_bf16 v[10:13], v[26:29], v[56:59], v[10:13]
    s_waitcnt vmcnt(2)
    v_and_b32_dpp v30, v24, v6 row_newbcast:8 row_mask:0xf bank_mask:0xf
    v_and_b32_dpp v31, v24, v7 row_newbcast:8 row_mask:0xf bank_mask:0xf
    v_and_b32_dpp v32, v24, v8 row_newbcast:8 row_mask:0xf bank_mask:0xf
    v_and_b32_dpp v33, v24, v9 row_newbcast:8 row_mask:0xf bank_mask:0xf
    s_nop 1
    v_mfma_f32_16x16x32_bf16 v[10:13], v[30:33], v[60:63], v[10:13]
    s_waitcnt vmcnt(1)
    v_and_b32_dpp v26, v24, v6 row_newbcast:4 row_mask:0xf bank_mask:0xf
    v_and_b32_dpp v27, v24, v7 row_newbcast:4 row_mask:0xf bank_mask:0xf
    v_and_b32_dpp v28, v24, v8 row_newbcast:4 row_mask:0xf bank_mask:0xf
    v_and_b32_dpp v29, v24, v9 row_newbcast:4 row_mask:0xf bank_mask:0xf
    s_nop 1
    v_mfma_f32_16x16x32_bf16 v[10:13], v[26:29], v[64:67], v[10:13]
    s_waitcnt vmcnt(0)
    v_and_b32_dpp v30, v24, v6 row_newbcast:12 row_mask:0xf bank_mask:0xf
    v_and_b32_dpp v31, v24, v7 row_newbcast:12 row_mask:0xf bank_mask:0xf
    v_and_b32_dpp v32, v24, v8 row_newbcast:12 row_mask:0xf bank_mask:0xf
    v_and_b32_dpp v33, v24, v9 row_newbcast:12 row_mask:0xf bank_mask:0xf
    s_nop 1
    v_mfma_f32_16x16x32_bf16 v[10:13], v[30:33], v[68:71], v[10:13]
    s_branch L_done
L_drainB:
    s_waitcnt vmcnt(7)
    v_dot2_f32_bf16 v17, v136, v2, 0
    v_dot2_f32_bf16 v17, v137, v3, v17
    v_dot2_f32_bf16 v17, v138, v4, v17
    v_dot2_f32_bf16 v17, v139, v5, v17
    s_waitcnt vmcnt(6)
    v_dot2_f32_bf16 v18, v140, v2, 0
    v_dot2_f32_bf16 v18, v141, v3, v18
    v_dot2_f32_bf16 v18, v142, v4, v18
    v_dot2_f32_bf16 v18, v143, v5, v18
    s_waitcnt vmcnt(5)
    v_dot2_f32_bf16 v19, v144, v2, 0
    v_dot2_f32_bf16 v19, v145, v3, v19
    v_dot2_f32_bf16 v19, v146, v4, v19
    v_dot2_f32_bf16 v19, v147, v5, v19
    s_waitcnt vmcnt(4)
    v_dot2_f32_bf16 v20, v148, v2, 0
    v_dot2_f32_bf16 v20, v149, v3, v20
    v_dot2_f32_bf16 v20, v150, v4, v20
    v_dot2_f32_bf16 v20, v151, v5, v20
    s_nop 2
    v_add_f32_dpp v21, v17, v17 row_ror:8 row_mask:0xf bank_mask:0x3
    v_add_f32_dpp v22, v19, v19 row_ror:8 row_mask:0xf bank_mask:0x3
    v_add_f32_dpp v21, v18, v18 row_ror:8 row_mask:0xf bank_mask:0xc
    v_add_f32_dpp v22, v20, v20 row_ror:8 row_mask:0xf bank_mask:0xc
    s_nop 0
    v_add_f32_dpp v23, v21, v21 row_shl:4 row_mask:0xf bank_mask:0x5
    v_add_f32_dpp v23, v22, v22 row_shr:4 row_mask:0xf bank_mask:0xa
    s_nop 1
    v_add_f32_dpp v23, v23, v23 quad_perm:[2,3,0,1] row_mask:0xf bank_mask:0xf
    s_nop 1
    v_add_f32_dpp v23, v23, v23 quad_perm:[1,0,3,2] row_mask:0xf bank_mask:0xf
    v_cvt_pk_bf16_f32 v23, v23, v23
    v_and_b32 v23, 0xffff0000, v23
    v_mul_f32 v23, s18, v23
    v_cvt_pk_bf16_f32 v23, v23, v23
    v_and_b32 v23, 0xffff0000, v23
    v_cmp_gt_f32 vcc, v23, v14
    s_cbranch_vccz L_back_23
    s_call_b64 s[46:47], L_rare
L_back_23:
    v_sub_f32 v21, v23, v14
    v_mul_f32 v21, s19, v21
    v_exp_f32 v21, v21
    s_nop 0
    v_add_f32 v16, v16, v21
    v_cvt_pk_bf16_f32 v24, v21, v21
    s_nop 1
    s_waitcnt vmcnt(3)
    v_and_b32_dpp v26, v24, v6 row_newbcast:0 row_mask:0xf bank_mask:0xf
    v_and_b32_dpp v27, v24, v7 row_newbcast:0 row_mask:0xf bank_mask:0xf
    v_and_b32_dpp v28, v24, v8 row_newbcast:0 row_mask:0xf bank_mask:0xf
    v_and_b32_dpp v29, v24, v9 row_newbcast:0 row_mask:0xf bank_mask:0xf
    s_nop 1
    v_mfma_f32_16x16x32_bf16 v[10:13], v[26:29], v[152:155], v[10:13]
    s_waitcnt vmcnt(2)
    v_and_b32_dpp v30, v24, v6 row_newbcast:8 row_mask:0xf bank_mask:0xf
    v_and_b32_dpp v31, v24, v7 row_newbcast:8 row_mask:0xf bank_mask:0xf
    v_and_b32_dpp v32, v24, v8 row_newbcast:8 row_mask:0xf bank_mask:0xf
    v_and_b32_dpp v33, v24, v9 row_newbcast:8 row_mask:0xf bank_mask:0xf
    s_nop 1
    v_mfma_f32_16x16x32_bf16 v[10:13], v[30:33], v[156:159], v[10:13]
    s_waitcnt vmcnt(1)
    v_and_b32_dpp v26, v24, v6 row_newbcast:4 row_mask:0xf bank_mask:0xf
    v_and_b32_dpp v27, v24, v7 row_newbcast:4 row_mask:0xf bank_mask:0xf
    v_and_b32_dpp v28, v24, v8 row_newbcast:4 row_mask:0xf bank_mask:0xf
    v_and_b32_dpp v29, v24, v9 row_newbcast:4 row_mask:0xf bank_mask:0xf
    s_nop 1
    v_mfma_f32_16x16x32_bf16 v[10:13], v[26:29], v[160:163], v[10:13]
    s_waitcnt vmcnt(0)
    v_and_b32_dpp v30, v24, v6 row_newbcast:12 row_mask:0xf bank_mask:0xf
    v_and_b32_dpp v31, v24, v7 row_newbcast:12 row_mask:0xf bank_mask:0xf
    v_and_b32_dpp v32, v24, v8 row_newbcast:12 row_mask:0xf bank_mask:0xf
    v_and_b32_dpp v33, v24, v9 row_newbcast:12 row_mask:0xf bank_mask:0xf
    s_nop 1
    v_mfma_f32_16x16x32_bf16 v[10:13], v[30:33], v[164:167], v[10:13]
    s_branch L_done
L_fin_last:
    s_waitcnt vmcnt(2)
    v_and_b32_dpp v30, v24, v6 row_newbcast:8 row_mask:0xf bank_mask:0xf
    v_and_b32_dpp v31, v24, v7 row_newbcast:8 row_mask:0xf bank_mask:0xf
    v_and_b32_dpp v32, v24, v8 row_newbcast:8 row_mask:0xf bank_mask:0xf
    v_and_b32_dpp v33, v24, v9 row_newbcast:8 row_mask:0xf bank_mask:0xf
    s_nop 1
    v_mfma_f32_16x16x32_bf16 v[10:13], v[30:33], v[156:159], v[10:13]
    s_waitcnt vmcnt(1)
    v_and_b32_dpp v26, v24, v6 row_newbcast:4 row_mask:0xf bank_mask:0xf
    v_and_b32_dpp v27, v24, v7 row_newbcast:4 row_mask:0xf bank_mask:0xf
    v_and_b32_dpp v28, v24, v8 row_newbcast:4 row_mask:0xf bank_mask:0xf
    v_and_b32_dpp v29, v24, v9 row_newbcast:4 row_mask:0xf bank_mask:0xf
    s_nop 1
    v_mfma_f32_16x16x32_bf16 v[10:13], v[26:29], v[160:163], v[10:13]
    s_waitcnt vmcnt(0)
    v_and_b32_dpp v30, v24, v6 row_newbcast:12 row_mask:0xf bank_mask:0xf
    v_and_b32_dpp v31, v24, v7 row_newbcast:12 row_mask:0xf bank_mask:0xf
    v_and_b32_dpp v32, v24, v8 row_newbcast:12 row_mask:0xf bank_mask:0xf
    v_and_b32_dpp v33, v24, v9 row_newbcast:12 row_mask:0xf bank_mask:0xf
    s_nop 1
    v_mfma_f32_16x16x32_bf16 v[10:13], v[30:33], v[164:167], v[10:13]
L_done:
    v_add_f32_dpp v16, v16, v16 row_ror:4 row_mask:0xf bank_mask:0xf
    s_lshl_b32 s20, 1, s3
    v_mov_b32 v21, 0
    v_add_f32_dpp v16, v16, v16 row_ror:8 row_mask:0xf bank_mask:0xf
    v_mov_b32 v22, s20
    s_nop 0
    v_add_f32_dpp v16, v16, v16 row_bcast:15 row_mask:0xa bank_mask:0xf
    s_nop 1
    v_add_f32_dpp v16, v16, v16 row_bcast:31 row_mask:0xc bank_mask:0xf
    s_nop 1
    ds_write_b128 v35, v[10:13] offset:5376
    v_mov_b32 v15, v16
    s_mov_b32 exec_lo, 0
    s_mov_b32 exec_hi, 0x80000000
    ds_write_b64 v25, v[14:15] offset:5184
    s_waitcnt lgkmcnt(0)
    s_barrier
    s_endpgm
L_rare:
    v_max_f32_dpp v21, v23, v23 row_ror:4 row_mask:0xf bank_mask:0xf
    s_nop 1
    v_max_f32_dpp v21, v21, v21 row_ror:8 row_mask:0xf bank_mask:0xf
    s_nop 0
    v_readlane_b32 s20, v21, 0
    v_readlane_b32 s21, v21, 16
    v_readlane_b32 s22, v21, 32
    v_readlane_b32 s23, v21, 48
    v_max_f32 v22, s20, v14
    v_max_f32 v22, s21, v22
    v_max_f32 v22, s22, v22
    v_max_f32 v22, s23, v22
    v_sub_f32 v21, v14, v22
    v_mul_f32 v21, s19, v21
    v_exp_f32 v21, v21
    v_mov_b32 v14, v22
    v_mul_f32 v10, v10, v21
    v_mul_f32 v11, v11, v21
    v_mul_f32 v12, v12, v21
    v_mul_f32 v13, v13, v21
    v_mul_f32 v16, v16, v21
    s_setpc_b64 s[46:47]
L_helper:
    s_setprio 2
    s_sub_u32 s3, s3, 8
    s_load_dwordx2 s[24:25], s[0:1], 0
    s_load_dwordx4 s[28:31], s[0:1], 24
    s_load_dwordx4 s[32:35], s[0:1], 48
    s_load_dwordx4 s[36:39], s[0:1], 64
    s_load_dwordx4 s[48:51], s[0:1], 80
    s_memrealtime s[66:67]
    s_mov_b32 s88, 0x80000
    v_mov_b32 v12, 0
    v_mov_b32 v13, 0
    v_mov_b32 v14, 0
    v_mov_b32 v15, 0
    v_lshlrev_b32 v14, 2, v2
    ds_write_b32 v14, v12 offset:4672
    ds_write_b32 v14, v12 offset:4928
    v_lshrrev_b32 v3, 5, v2
    v_and_b32 v4, 31, v2
    v_lshrrev_b32 v5, 4, v2
    v_and_b32 v6, 15, v2
    s_lshl_b32 s52, s3, 9
    v_lshlrev_b32 v7, 8, v3
    v_lshl_add_u32 v7, v4, 3, v7
    s_add_u32 s53, s52, 0
    v_add_u32 v7, s53, v7
    v_and_b32 v8, 1, v2
    v_lshlrev_b32 v8, 8, v8
    v_lshl_add_u32 v8, v5, 4, v8
    v_add_u32 v8, s53, v8
    s_add_u32 s53, s52, 2048
    v_lshlrev_b32 v9, 2, v2
    v_add_u32 v9, s53, v9
    s_waitcnt lgkmcnt(0)
    s_mov_b32 s84, s98
    s_mov_b32 s85, s99
    s_mov_b32 s86, 536870912
    s_mov_b32 s87, 0x20000
    s_mov_b32 s76, s96
    s_mov_b32 s77, s97
    s_mov_b32 s78, 256
    s_mov_b32 s79, 0x20000
    s_or_b32 s54, s2, s3
    s_cmp_eq_u32 s54, 0
    s_cbranch_scc0 L_notagw
    s_or_b32 s66, s66, 1
    v_mov_b32 v12, s66
    s_mov_b64 exec, 1
    buffer_atomic_cmpswap v[12:13], off, s[76:79], 0 sc1
    s_mov_b64 exec, -1
L_notagw:
    s_mov_b32 s20, s24
    s_mov_b32 s21, s25
    s_mov_b32 s22, 2048
    s_mov_b32 s23, 0x20000
    s_add_u32 s16, s98, 622592
    s_addc_u32 s17, s99, 0
    s_mov_b32 s18, 5504
    s_mov_b32 s19, 0x20000
    s_mov_b32 s72, s50
    s_mov_b32 s73, s51
    s_mov_b32 s74, 2048
    s_mov_b32 s75, 0x20000
    v_mov_b32 v10, 0
    v_mov_b32 v11, 0
    v_mov_b32 v12, 0
    v_mov_b32 v13, 0
    v_mov_b32 v14, 0
    v_mov_b32 v15, 0
    v_mov_b32 v16, 0
    v_mov_b32 v17, 0
    v_mov_b32 v18, 0
    v_mov_b32 v19, 0
    v_mov_b32 v20, 0
    v_mov_b32 v21, 0
    v_mov_b32 v22, 0
    v_mov_b32 v23, 0
    s_mov_b32 s54, 0
    s_mov_b32 s55, 0
    s_mov_b32 s56, 0
    s_mov_b32 s57, 0
    s_mov_b32 s59, 0
    s_mov_b32 s60, 0
    s_mov_b32 s61, 0
    s_mov_b32 s62, 0
    s_lshl_b32 s83, s40, 3
    s_add_u32 s83, s83, s41
    s_lshl_b32 s83, s83, 10
    s_add_u32 s83, s83, 65536
    s_mov_b32 s82, s40
    s_mov_b32 s81, s41
    s_mov_b32 s67, s83
    s_mov_b32 s45, s82
    s_lshl_b32 s82, s82, 7
    s_add_u32 s82, s82, 630784
    s_mov_b32 s44, 0
    s_cmp_lt_u32 s89, 48
    s_cbranch_scc1 L_pro_mod
    s_sub_u32 s54, s89, 48
    s_cmp_lt_u32 s54, 64
    s_cbranch_scc1 L_pro_q
    s_barrier
    s_branch L_common1
L_pro_mod:
    s_mov_b32 s12, s38
    s_mov_b32 s13, s39
    s_mov_b32 s14, 2048
    s_mov_b32 s15, 0x20000
    v_lshlrev_b32 v120, 10, v3
    v_lshl_add_u32 v120, v4, 3, v120
    s_lshl_b32 s54, s3, 8
    buffer_load_dwordx2 v[122:123], v120, s[12:15], s54 offen
    s_mov_b32 s8, s48
    s_mov_b32 s9, s49
    s_mov_b32 s10, 3145728
    s_mov_b32 s11, 0x20000
    s_lshl_b32 s56, s89, 7
    s_lshl_b32 s54, s3, 7
    v_lshrrev_b32 v11, 3, v2
    v_add_u32 v11, s54, v11
    s_mov_b32 s55, 6144
    v_mul_lo_u32 v11, v11, s55
    v_and_b32 v120, 7, v2
    v_lshl_add_u32 v11, v120, 4, v11
    v_add_u32 v11, s56, v11
    s_lshl_b32 s57, s3, 14
    s_mov_b32 s70, 0
    s_add_u32 s71, s57, 21760
    s_mov_b32 m0, s71
    s_add_u32 s71, s71, 1024
    buffer_load_dwordx4 v11, s[8:11], s70 offen nt lds
    s_add_u32 s70, s70, 49152
    s_mov_b32 m0, s71
    s_add_u32 s71, s71, 1024
    buffer_load_dwordx4 v11, s[8:11], s70 offen nt lds
    s_add_u32 s70, s70, 49152
    s_mov_b32 m0, s71
    s_add_u32 s71, s71, 1024
    buffer_load_dwordx4 v11, s[8:11], s70 offen nt lds
    s_add_u32 s70, s70, 49152
    s_mov_b32 m0, s71
    s_add_u32 s71, s71, 1024
    buffer_load_dwordx4 v11, s[8:11], s70 offen nt lds
    s_add_u32 s70, s70, 49152
    s_mov_b32 m0, s71
    s_add_u32 s71, s71, 1024
    buffer_load_dwordx4 v11, s[8:11], s70 offen nt lds
    s_add_u32 s70, s70, 49152
    s_mov_b32 m0, s71
    s_add_u32 s71, s71, 1024
    buffer_load_dwordx4 v11, s[8:11], s70 offen nt lds
    s_add_u32 s70, s70, 49152
    s_mov_b32 m0, s71
    s_add_u32 s71, s71, 1024
    buffer_load_dwordx4 v11, s[8:11], s70 offen nt lds
    s_add_u32 s70, s70, 49152
    s_mov_b32 m0, s71
    s_add_u32 s71, s71, 1024
    buffer_load_dwordx4 v11, s[8:11], s70 offen nt lds
    s_add_u32 s70, s70, 49152
    s_mov_b32 m0, s71
    s_add_u32 s71, s71, 1024
    buffer_load_dwordx4 v11, s[8:11], s70 offen nt lds
    s_add_u32 s70, s70, 49152
    s_mov_b32 m0, s71
    s_add_u32 s71, s71, 1024
    buffer_load_dwordx4 v11, s[8:11], s70 offen nt lds
    s_add_u32 s70, s70, 49152
    s_mov_b32 m0, s71
    s_add_u32 s71, s71, 1024
    buffer_load_dwordx4 v11, s[8:11], s70 offen nt lds
    s_add_u32 s70, s70, 49152
    s_mov_b32 m0, s71
    s_add_u32 s71, s71, 1024
    buffer_load_dwordx4 v11, s[8:11], s70 offen nt lds
    s_add_u32 s70, s70, 49152
    s_mov_b32 m0, s71
    s_add_u32 s71, s71, 1024
    buffer_load_dwordx4 v11, s[8:11], s70 offen nt lds
    s_add_u32 s70, s70, 49152
    s_mov_b32 m0, s71
    s_add_u32 s71, s71, 1024
    buffer_load_dwordx4 v11, s[8:11], s70 offen nt lds
    s_add_u32 s70, s70, 49152
    s_mov_b32 m0, s71
    s_add_u32 s71, s71, 1024
    buffer_load_dwordx4 v11, s[8:11], s70 offen nt lds
    s_add_u32 s70, s70, 49152
    s_mov_b32 m0, s71
    s_add_u32 s71, s71, 1024
    buffer_load_dwordx4 v11, s[8:11], s70 offen nt lds
    s_add_u32 s70, s70, 49152
    s_barrier
L_mod_nob1:
    v_lshrrev_b32 v10, 2, v6
    v_lshl_add_u32 v10, v5, 3, v10
    v_lshlrev_b32 v10, 7, v10
    v_and_b32 v120, 3, v6
    v_lshl_add_u32 v10, v120, 3, v10
    s_lshl_b32 s54, s3, 14
    s_add_u32 s54, s54, 21760
    v_add_u32 v10, s54, v10
    s_waitcnt vmcnt(16)
    v_lshlrev_b32 v124, 16, v122
    v_and_b32 v125, 0xffff0000, v122
    v_lshlrev_b32 v126, 16, v123
    v_and_b32 v127, 0xffff0000, v123
    s_mov_b32 s58, 0xbfb8aa3b
    v_mul_f32 v128, s58, v124
    v_mul_f32 v129, s58, v125
    v_mul_f32 v130, s58, v126
    v_mul_f32 v131, s58, v127
    v_exp_f32 v128, v128
    v_exp_f32 v129, v129
    v_exp_f32 v130, v130
    v_exp_f32 v131, v131
    s_nop 0
    v_add_f32 v128, 1.0, v128
    v_add_f32 v129, 1.0, v129
    v_add_f32 v130, 1.0, v130
    v_add_f32 v131, 1.0, v131
    v_rcp_f32 v128, v128
    v_rcp_f32 v129, v129
    v_rcp_f32 v130, v130
    v_rcp_f32 v131, v131
    s_nop 0
    v_mul_f32 v124, v124, v128
    v_mul_f32 v125, v125, v129
    v_mul_f32 v126, v126, v130
    v_mul_f32 v127, v127, v131
    v_cvt_pk_bf16_f32 v132, v124, v125
    v_cvt_pk_bf16_f32 v133, v126, v127
    ds_write_b64 v7, v[132:133]
    s_lshr_b32 s60, s89, 3
    s_lshl_b32 s60, s60, 12
    s_and_b32 s61, s89, 7
    s_lshl_b32 s61, s61, 8
    s_add_u32 s60, s60, s61
    s_add_u32 s60, s60, 0
    s_mov_b32 s61, 2048
    s_mov_b32 s62, 0
    s_branch L_common1
L_pro_q:
    v_lshlrev_b32 v120, 10, v3
    v_lshl_add_u32 v121, v4, 5, v120
    buffer_load_dwordx4 v[124:127], v121, s[20:23], 0 offen
    buffer_load_dwordx4 v[128:131], v121, s[20:23], 0 offen offset:16
    v_lshl_add_u32 v120, v4, 3, v120
    s_lshl_b32 s54, s3, 8
    buffer_load_dwordx2 v[122:123], v120, s[20:23], s54 offen
    s_mov_b32 s8, s28
    s_mov_b32 s9, s29
    s_mov_b32 s10, 4194304
    s_mov_b32 s11, 0x20000
    s_sub_u32 s59, s89, 48
    s_lshl_b32 s56, s59, 7
    s_lshl_b32 s54, s3, 7
    v_lshrrev_b32 v11, 3, v2
    v_add_u32 v11, s54, v11
    s_mov_b32 s55, 8192
    v_mul_lo_u32 v11, v11, s55
    v_and_b32 v120, 7, v2
    v_lshl_add_u32 v11, v120, 4, v11
    v_add_u32 v11, s56, v11
    s_lshl_b32 s57, s3, 14
    s_mov_b32 s70, 0
    s_add_u32 s71, s57, 21760
    s_mov_b32 m0, s71
    s_add_u32 s71, s71, 1024
    buffer_load_dwordx4 v11, s[8:11], s70 offen nt lds
    s_add_u32 s70, s70, 65536
    s_mov_b32 m0, s71
    s_add_u32 s71, s71, 1024
    buffer_load_dwordx4 v11, s[8:11], s70 offen nt lds
    s_add_u32 s70, s70, 65536
    s_mov_b32 m0, s71
    s_add_u32 s71, s71, 1024
    buffer_load_dwordx4 v11, s[8:11], s70 offen nt lds
    s_add_u32 s70, s70, 65536
    s_mov_b32 m0, s71
    s_add_u32 s71, s71, 1024
    buffer_load_dwordx4 v11, s[8:11], s70 offen nt lds
    s_add_u32 s70, s70, 65536
    s_mov_b32 m0, s71
    s_add_u32 s71, s71, 1024
    buffer_load_dwordx4 v11, s[8:11], s70 offen nt lds
    s_add_u32 s70, s70, 65536
    s_mov_b32 m0, s71
    s_add_u32 s71, s71, 1024
    buffer_load_dwordx4 v11, s[8:11], s70 offen nt lds
    s_add_u32 s70, s70, 65536
    s_mov_b32 m0, s71
    s_add_u32 s71, s71, 1024
    buffer_load_dwordx4 v11, s[8:11], s70 offen nt lds
    s_add_u32 s70, s70, 65536
    s_mov_b32 m0, s71
    s_add_u32 s71, s71, 1024
    buffer_load_dwordx4 v11, s[8:11], s70 offen nt lds
    s_add_u32 s70, s70, 65536
    s_mov_b32 m0, s71
    s_add_u32 s71, s71, 1024
    buffer_load_dwordx4 v11, s[8:11], s70 offen nt lds
    s_add_u32 s70, s70, 65536
    s_mov_b32 m0, s71
    s_add_u32 s71, s71, 1024
    buffer_load_dwordx4 v11, s[8:11], s70 offen nt lds
    s_add_u32 s70, s70, 65536
    s_mov_b32 m0, s71
    s_add_u32 s71, s71, 1024
    buffer_load_dwordx4 v11, s[8:11], s70 offen nt lds
    s_add_u32 s70, s70, 65536
    s_mov_b32 m0, s71
    s_add_u32 s71, s71, 1024
    buffer_load_dwordx4 v11, s[8:11], s70 offen nt lds
    s_add_u32 s70, s70, 65536
    s_mov_b32 m0, s71
    s_add_u32 s71, s71, 1024
    buffer_load_dwordx4 v11, s[8:11], s70 offen nt lds
    s_add_u32 s70, s70, 65536
    s_mov_b32 m0, s71
    s_add_u32 s71, s71, 1024
    buffer_load_dwordx4 v11, s[8:11], s70 offen nt lds
    s_add_u32 s70, s70, 65536
    s_mov_b32 m0, s71
    s_add_u32 s71, s71, 1024
    buffer_load_dwordx4 v11, s[8:11], s70 offen nt lds
    s_add_u32 s70, s70, 65536
    s_mov_b32 m0, s71
    s_add_u32 s71, s71, 1024
    buffer_load_dwordx4 v11, s[8:11], s70 offen nt lds
    s_add_u32 s70, s70, 65536
    s_barrier
    v_lshrrev_b32 v10, 2, v6
    v_lshl_add_u32 v10, v5, 3, v10
    v_lshlrev_b32 v10, 7, v10
    v_and_b32 v120, 3, v6
    v_lshl_add_u32 v10, v120, 3, v10
    s_lshl_b32 s54, s3, 14
    s_add_u32 s54, s54, 21760
    v_add_u32 v10, s54, v10
    s_waitcnt vmcnt(16)
    v_mov_b32 v132, 0
    v_mov_b32 v133, 0
    v_lshlrev_b32 v134, 16, v124
    v_and_b32 v135, 0xffff0000, v124
    v_add_f32 v132, v132, v134
    v_fmac_f32 v133, v134, v134
    v_add_f32 v132, v132, v135
    v_fmac_f32 v133, v135, v135
    v_lshlrev_b32 v134, 16, v125
    v_and_b32 v135, 0xffff0000, v125
    v_add_f32 v132, v132, v134
    v_fmac_f32 v133, v134, v134
    v_add_f32 v132, v132, v135
    v_fmac_f32 v133, v135, v135
    v_lshlrev_b32 v134, 16, v126
    v_and_b32 v135, 0xffff0000, v126
    v_add_f32 v132, v132, v134
    v_fmac_f32 v133, v134, v134
    v_add_f32 v132, v132, v135
    v_fmac_f32 v133, v135, v135
    v_lshlrev_b32 v134, 16, v127
    v_and_b32 v135, 0xffff0000, v127
    v_add_f32 v132, v132, v134
    v_fmac_f32 v133, v134, v134
    v_add_f32 v132, v132, v135
    v_fmac_f32 v133, v135, v135
    v_lshlrev_b32 v134, 16, v128
    v_and_b32 v135, 0xffff0000, v128
    v_add_f32 v132, v132, v134
    v_fmac_f32 v133, v134, v134
    v_add_f32 v132, v132, v135
    v_fmac_f32 v133, v135, v135
    v_lshlrev_b32 v134, 16, v129
    v_and_b32 v135, 0xffff0000, v129
    v_add_f32 v132, v132, v134
    v_fmac_f32 v133, v134, v134
    v_add_f32 v132, v132, v135
    v_fmac_f32 v133, v135, v135
    v_lshlrev_b32 v134, 16, v130
    v_and_b32 v135, 0xffff0000, v130
    v_add_f32 v132, v132, v134
    v_fmac_f32 v133, v134, v134
    v_add_f32 v132, v132, v135
    v_fmac_f32 v133, v135, v135
    v_lshlrev_b32 v134, 16, v131
    v_and_b32 v135, 0xffff0000, v131
    v_add_f32 v132, v132, v134
    v_fmac_f32 v133, v134, v134
    v_add_f32 v132, v132, v135
    v_fmac_f32 v133, v135, v135
    s_nop 0
    v_add_f32_dpp v132, v132, v132 row_ror:8 row_mask:0xf bank_mask:0xf
    v_add_f32_dpp v133, v133, v133 row_ror:8 row_mask:0xf bank_mask:0xf
    s_nop 0
    v_add_f32_dpp v132, v132, v132 row_ror:4 row_mask:0xf bank_mask:0xf
    v_add_f32_dpp v133, v133, v133 row_ror:4 row_mask:0xf bank_mask:0xf
    s_nop 0
    v_add_f32_dpp v132, v132, v132 row_ror:2 row_mask:0xf bank_mask:0xf
    v_add_f32_dpp v133, v133, v133 row_ror:2 row_mask:0xf bank_mask:0xf
    s_nop 0
    v_add_f32_dpp v132, v132, v132 row_ror:1 row_mask:0xf bank_mask:0xf
    v_add_f32_dpp v133, v133, v133 row_ror:1 row_mask:0xf bank_mask:0xf
    v_mov_b32 v134, v132
    v_mov_b32 v135, v133
    s_nop 1
    v_permlane16_swap_b32 v132, v134
    v_permlane16_swap_b32 v133, v135
    s_nop 0
    v_add_f32 v132, v132, v134
    v_add_f32 v133, v133, v135
    v_lshlrev_b32 v136, 16, v122
    v_and_b32 v137, 0xffff0000, v122
    v_lshlrev_b32 v138, 16, v123
    v_and_b32 v139, 0xffff0000, v123
    s_mov_b32 s58, 0x3b000000
    v_mul_f32 v132, s58, v132
    v_mul_f32 v133, s58, v133
    v_fma_f32 v133, -v132, v132, v133
    v_max_f32 v133, 0, v133
    v_cvt_pk_bf16_f32 v134, v132, v133
    v_lshlrev_b32 v132, 16, v134
    v_and_b32 v133, 0xffff0000, v134
    v_add_f32 v133, 0x3727c5ac, v133
    v_cvt_pk_bf16_f32 v133, v133, v133
    v_and_b32 v133, 0xffff0000, v133
    v_sqrt_f32 v133, v133
    v_sub_f32 v136, v136, v132
    v_sub_f32 v137, v137, v132
    v_sub_f32 v138, v138, v132
    v_sub_f32 v139, v139, v132
    v_cvt_pk_bf16_f32 v133, v133, v133
    v_and_b32 v133, 0xffff0000, v133
    v_rcp_f32 v133, v133
    v_cvt_pk_bf16_f32 v134, v136, v137
    v_lshlrev_b32 v136, 16, v134
    v_and_b32 v137, 0xffff0000, v134
    v_cvt_pk_bf16_f32 v135, v138, v139
    v_lshlrev_b32 v138, 16, v135
    v_and_b32 v139, 0xffff0000, v135
    v_mul_f32 v136, v136, v133
    v_mul_f32 v137, v137, v133
    v_mul_f32 v138, v138, v133
    v_mul_f32 v139, v139, v133
    v_cvt_pk_bf16_f32 v134, v136, v137
    v_lshlrev_b32 v136, 16, v134
    v_and_b32 v137, 0xffff0000, v134
    v_cvt_pk_bf16_f32 v135, v138, v139
    v_lshlrev_b32 v138, 16, v135
    v_and_b32 v139, 0xffff0000, v135
    s_lshl_b32 s60, s59, 8
    s_add_u32 s60, s60, 32768
    s_mov_b32 s61, 16384
    s_mov_b32 s62, 1
L_common1:
    buffer_load_dword v165, off, s[76:79], 0 sc1
    v_mov_b32 v144, -1
    v_mov_b32 v145, -1
    v_mov_b32 v146, -1
    v_mov_b32 v147, -1
    s_cmp_eq_u32 s3, 3
    s_cbranch_scc0 L_noclear
    v_lshlrev_b32 v148, 4, v2
    s_mov_b32 exec_lo, -1
    s_mov_b32 exec_hi, 1
    buffer_store_dwordx4 v[144:147], v148, s[84:87], s83 offen sc1
    s_mov_b64 exec, -1
    s_sub_u32 s64, s89, 112
    s_cmp_lt_u32 s64, 64
    s_cbranch_scc0 L_noclr_wo
    s_sub_u32 s64, s89, 112
    s_and_b32 s68, s64, 7
    s_lshr_b32 s64, s64, 3
    s_min_u32 s69, s68, 0
    s_mul_i32 s68, s68, 8
    s_add_u32 s64, s64, s68
    s_add_u32 s64, s64, s69
    s_lshr_b32 s65, s64, 3
    s_lshl_b32 s65, s65, 12
    s_and_b32 s66, s64, 7
    s_lshl_b32 s66, s66, 8
    s_add_u32 s65, s65, s66
    s_add_u32 s65, s65, 589824
    v_lshlrev_b32 v148, 11, v5
    v_lshl_add_u32 v148, v6, 4, v148
    s_mov_b32 exec_hi, 0
    buffer_store_dwordx4 v[144:147], v148, s[84:87], s65 offen sc1
    s_mov_b64 exec, -1
L_noclr_wo:
    s_sub_u32 s64, s89, 192
    s_cmp_lt_u32 s64, 43
    s_cbranch_scc0 L_noclr_up
    s_sub_u32 s64, s89, 192
    s_and_b32 s68, s64, 7
    s_lshr_b32 s64, s64, 3
    s_min_u32 s69, s68, 3
    s_mul_i32 s68, s68, 5
    s_add_u32 s64, s64, s68
    s_add_u32 s64, s64, s69
    s_lshl_b32 s65, s64, 7
    s_add_u32 s65, s65, 622592
    v_lshlrev_b32 v148, 4, v2
    s_mov_b64 exec, 0xff
    buffer_store_dwordx4 v[144:147], v148, s[84:87], s65 offen sc1
    s_mov_b64 exec, -1
L_noclr_up:
    s_cmp_eq_u32 s81, 0
    s_cbranch_scc0 L_noclr_cnt
    v_mov_b32 v148, 48
    s_mul_i32 s65, s45, 4224
    s_add_u32 s65, s65, 1048576
    s_mov_b64 exec, 1
    buffer_store_dword v148, off, s[84:87], s65 sc1
    s_mov_b64 exec, -1
L_noclr_cnt:
L_noclear:
    s_waitcnt vmcnt(0)
    v_cmp_eq_u32 vcc, 0, v165
    s_cbranch_vccz L_gottag
L_poll_24:
    buffer_load_dword v165, off, s[76:79], 0 sc1
    s_waitcnt vmcnt(0)
    v_cmp_eq_u32 vcc, 0, v165
    s_cbranch_vccz L_pdone_25
    s_cmp_eq_u32 s88, 0
    s_cbranch_scc1 L_pdone_25
    s_sub_u32 s88, s88, 1
    s_sleep 2
    s_branch L_poll_24
L_pdone_25:
L_gottag:
    v_readfirstlane_b32 s80, v165
    s_cmp_eq_u32 s3, 3
    s_cbranch_scc0 L_nocount
    s_and_b32 s63, s2, 3
    s_lshl_b32 s63, s63, 2
    s_add_u32 s63, s63, 128
    v_mov_b32 v149, 1
    s_mov_b64 exec, 1
    buffer_atomic_add v149, off, s[76:79], s63 sc1
    s_cmp_eq_u32 s81, 0
    s_cbranch_scc0 L_nocnttag
    v_mov_b32 v148, s80
    buffer_store_dword v148, off, s[84:87], s82 offset:64 sc1
L_nocnttag:
    s_mov_b64 exec, -1
L_nocount:
    s_cmp_lt_u32 s89, 112
    s_cbranch_scc0 L_qgather
L_gemv0:
    ds_read_b64_tr_b16 v[40:41], v10 offset:0
    ds_read_b64_tr_b16 v[42:43], v10 offset:512
    ds_read_b64_tr_b16 v[44:45], v10 offset:32
    ds_read_b64_tr_b16 v[46:47], v10 offset:544
    ds_read_b64_tr_b16 v[48:49], v10 offset:64
    ds_read_b64_tr_b16 v[50:51], v10 offset:576
    ds_read_b64_tr_b16 v[52:53], v10 offset:96
    ds_read_b64_tr_b16 v[54:55], v10 offset:608
    ds_read_b64_tr_b16 v[56:57], v10 offset:4096
    ds_read_b64_tr_b16 v[58:59], v10 offset:4608
    ds_read_b64_tr_b16 v[60:61], v10 offset:4128
    ds_read_b64_tr_b16 v[62:63], v10 offset:4640
    ds_read_b64_tr_b16 v[64:65], v10 offset:4160
    ds_read_b64_tr_b16 v[66:67], v10 offset:4672
    ds_read_b64_tr_b16 v[68:69], v10 offset:4192
    ds_read_b64_tr_b16 v[70:71], v10 offset:4704
    ds_read_b64_tr_b16 v[72:73], v10 offset:8192
    ds_read_b64_tr_b16 v[74:75], v10 offset:8704
    ds_read_b64_tr_b16 v[76:77], v10 offset:8224
    ds_read_b64_tr_b16 v[78:79], v10 offset:8736
    ds_read_b64_tr_b16 v[80:81], v10 offset:8256
    ds_read_b64_tr_b16 v[82:83], v10 offset:8768
    ds_read_b64_tr_b16 v[84:85], v10 offset:8288
    ds_read_b64_tr_b16 v[86:87], v10 offset:8800
    ds_read_b64_tr_b16 v[88:89], v10 offset:12288
    ds_read_b64_tr_b16 v[90:91], v10 offset:12800
    ds_read_b64_tr_b16 v[92:93], v10 offset:12320
    ds_read_b64_tr_b16 v[94:95], v10 offset:12832
    ds_read_b64_tr_b16 v[96:97], v10 offset:12352
    ds_read_b64_tr_b16 v[98:99], v10 offset:12864
    ds_read_b64_tr_b16 v[100:101], v10 offset:12384
    ds_read_b64_tr_b16 v[102:103], v10 offset:12896
    s_cmp_eq_u32 s62, 0
    s_cbranch_scc1 L_pro_gemv
    v_lshlrev_b32 v120, 11, v3
    v_lshl_add_u32 v120, v4, 4, v120
    s_lshl_b32 s54, s3, 9
    s_add_u32 s54, s54, 0
    s_add_u32 s55, s54, 4096
L_poll_26:
    buffer_load_dwordx4 v[124:127], v120, s[84:87], s55 offen sc1
    buffer_load_dwordx4 v[128:131], v120, s[84:87], s54 offen sc1
    s_waitcnt vmcnt(0)
    v_xor_b32 v121, s80, v125
    v_xor_b32 v122, s80, v127
    v_or_b32 v121, v121, v122
    v_xor_b32 v122, s80, v129
    v_or_b32 v121, v121, v122
    v_xor_b32 v122, s80, v131
    v_or_b32 v121, v121, v122
    v_cmp_ne_u32 vcc, 0, v121
    s_cbranch_vccz L_pdone_27
    s_cmp_eq_u32 s88, 0
    s_cbranch_scc1 L_pdone_27
    s_sub_u32 s88, s88, 1
    s_sleep 8
    s_branch L_poll_26
L_pdone_27:
    v_lshlrev_b32 v140, 16, v124
    v_and_b32 v141, 0xffff0000, v124
    v_lshlrev_b32 v142, 16, v126
    v_and_b32 v143, 0xffff0000, v126
    v_add_f32 v140, 1.0, v140
    v_add_f32 v141, 1.0, v141
    v_add_f32 v142, 1.0, v142
    v_add_f32 v143, 1.0, v143
    v_cvt_pk_bf16_f32 v121, v140, v141
    v_lshlrev_b32 v140, 16, v121
    v_and_b32 v141, 0xffff0000, v121
    v_cvt_pk_bf16_f32 v122, v142, v143
    v_lshlrev_b32 v142, 16, v122
    v_and_b32 v143, 0xffff0000, v122
    v_pk_mul_f32 v[136:137], v[136:137], v[140:141]
    v_pk_mul_f32 v[138:139], v[138:139], v[142:143]
    v_cvt_pk_bf16_f32 v121, v136, v137
    v_lshlrev_b32 v136, 16, v121
    v_and_b32 v137, 0xffff0000, v121
    v_cvt_pk_bf16_f32 v122, v138, v139
    v_lshlrev_b32 v138, 16, v122
    v_and_b32 v139, 0xffff0000, v122
    v_lshlrev_b32 v144, 16, v128
    v_and_b32 v145, 0xffff0000, v128
    v_lshlrev_b32 v146, 16, v130
    v_and_b32 v147, 0xffff0000, v130
    v_pk_add_f32 v[136:137], v[136:137], v[144:145]
    v_pk_add_f32 v[138:139], v[138:139], v[146:147]
    v_cvt_pk_bf16_f32 v148, v136, v137
    v_cvt_pk_bf16_f32 v149, v138, v139
    ds_write_b64 v7, v[148:149]
L_pro_gemv:
    ds_read_b128 v[24:27], v8 offset:0
    ds_read_b128 v[28:31], v8 offset:64
    ds_read_b128 v[32:35], v8 offset:128
    ds_read_b128 v[36:39], v8 offset:192
    s_waitcnt lgkmcnt(3)
    v_mfma_f32_16x16x32_bf16 v[104:107], v[24:27], v[40:43], 0
    v_mfma_f32_16x16x32_bf16 v[108:111], v[24:27], v[44:47], 0
    v_mfma_f32_16x16x32_bf16 v[112:115], v[24:27], v[48:51], 0
    v_mfma_f32_16x16x32_bf16 v[116:119], v[24:27], v[52:55], 0
    s_waitcnt lgkmcnt(2)
    v_mfma_f32_16x16x32_bf16 v[104:107], v[28:31], v[56:59], v[104:107]
    v_mfma_f32_16x16x32_bf16 v[108:111], v[28:31], v[60:63], v[108:111]
    v_mfma_f32_16x16x32_bf16 v[112:115], v[28:31], v[64:67], v[112:115]
    v_mfma_f32_16x16x32_bf16 v[116:119], v[28:31], v[68:71], v[116:119]
    s_waitcnt lgkmcnt(1)
    v_mfma_f32_16x16x32_bf16 v[104:107], v[32:35], v[72:75], v[104:107]
    v_mfma_f32_16x16x32_bf16 v[108:111], v[32:35], v[76:79], v[108:111]
    v_mfma_f32_16x16x32_bf16 v[112:115], v[32:35], v[80:83], v[112:115]
    v_mfma_f32_16x16x32_bf16 v[116:119], v[32:35], v[84:87], v[116:119]
    s_waitcnt lgkmcnt(0)
    v_mfma_f32_16x16x32_bf16 v[104:107], v[36:39], v[88:91], v[104:107]
    v_mfma_f32_16x16x32_bf16 v[108:111], v[36:39], v[92:95], v[108:111]
    v_mfma_f32_16x16x32_bf16 v[112:115], v[36:39], v[96:99], v[112:115]
    v_mfma_f32_16x16x32_bf16 v[116:119], v[36:39], v[100:103], v[116:119]
    s_nop 7
    v_mov_b32_dpp v120, v104 quad_perm:[0,1,2,3] row_mask:0x1 bank_mask:0xf
    v_mov_b32_dpp v121, v105 quad_perm:[0,1,2,3] row_mask:0x1 bank_mask:0xf
    v_mov_b32_dpp v120, v108 quad_perm:[0,1,2,3] row_mask:0x2 bank_mask:0xf
    v_mov_b32_dpp v121, v109 quad_perm:[0,1,2,3] row_mask:0x2 bank_mask:0xf
    v_mov_b32_dpp v120, v112 quad_perm:[0,1,2,3] row_mask:0x4 bank_mask:0xf
    v_mov_b32_dpp v121, v113 quad_perm:[0,1,2,3] row_mask:0x4 bank_mask:0xf
    v_mov_b32_dpp v120, v116 quad_perm:[0,1,2,3] row_mask:0x8 bank_mask:0xf
    v_mov_b32_dpp v121, v117 quad_perm:[0,1,2,3] row_mask:0x8 bank_mask:0xf
    ds_write_b32 v9, v120
    ds_write_b32 v9, v121 offset:256
    v_mov_b32 v122, 4672
    v_mov_b32 v123, 1
    s_mov_b64 exec, 1
    ds_add_rtn_u32 v124, v122, v123
    s_mov_b64 exec, -1
    s_waitcnt lgkmcnt(0)
    v_readfirstlane_b32 s54, v124
    s_cmp_eq_u32 s54, 3
    s_cbranch_scc0 L_qgather
    v_and_b32 v120, 1, v5
    v_lshlrev_b32 v120, 8, v120
    v_lshl_add_u32 v120, v6, 4, v120
    ds_read_b128 v[124:127], v120 offset:2048
    ds_read_b128 v[128:131], v120 offset:2560
    ds_read_b128 v[132:135], v120 offset:3072
    ds_read_b128 v[136:139], v120 offset:3584
    s_waitcnt lgkmcnt(0)
    v_pk_add_f32 v[124:125], v[124:125], v[128:129]
    v_pk_add_f32 v[126:127], v[126:127], v[130:131]
    v_pk_add_f32 v[132:133], v[132:133], v[136:137]
    v_pk_add_f32 v[134:135], v[134:135], v[138:139]
    v_pk_add_f32 v[124:125], v[124:125], v[132:133]
    v_pk_add_f32 v[126:127], v[126:127], v[134:135]
    v_cvt_pk_bf16_f32 v128, v124, v125
    v_mov_b32 v129, s80
    v_cvt_pk_bf16_f32 v130, v126, v127
    v_mov_b32 v131, s80
    v_mul_lo_u32 v120, v5, s61
    v_lshl_add_u32 v120, v6, 4, v120
    s_mov_b32 exec_hi, 0
    buffer_store_dwordx4 v[128:131], v120, s[84:87], s60 offen sc1
    s_mov_b64 exec, -1
L_qgather:
    s_cmp_eq_u32 s3, 3
    s_cbranch_scc0 L_qg2
L_poll_28:
    buffer_load_dword v120, off, s[84:87], s82 offset:64 sc1
    s_waitcnt vmcnt(0)
    v_cmp_ne_u32 vcc, s80, v120
    s_cbranch_vccz L_pdone_29
    s_cmp_eq_u32 s88, 0
    s_cbranch_scc1 L_pdone_29
    s_sub_u32 s88, s88, 1
    s_sleep 8
    s_branch L_poll_28
L_pdone_29:
    v_mov_b32 v120, 0
    v_mov_b32 v121, 1
    ds_write_b32 v120, v121 offset:4692
L_qg2:
    s_cmp_eq_u32 s3, 0
    s_cbranch_scc0 L_b2
    s_lshl_b32 s54, s45, 9
    s_add_u32 s54, s54, 32768
    s_xor_b32 s55, s45, 33
    s_lshl_b32 s55, s55, 9
    s_add_u32 s55, s55, 32768
    v_lshlrev_b32 v120, 3, v2
L_poll_30:
    buffer_load_dwordx2 v[122:123], v120, s[84:87], s54 offen sc1
    s_waitcnt vmcnt(0)
    v_xor_b32 v126, s80, v123
    v_cmp_ne_u32 vcc, 0, v126
    s_cbranch_vccz L_pdone_31
    s_cmp_eq_u32 s88, 0
    s_cbranch_scc1 L_pdone_31
    s_sub_u32 s88, s88, 1
    s_sleep 16
    s_branch L_poll_30
L_pdone_31:
    v_lshlrev_b32 v120, 2, v2
    ds_write_b32 v120, v122 offset:4160
    v_mov_b32 v120, 0
    v_mov_b32 v121, 1
    ds_write_b32 v120, v121 offset:4688
    s_waitcnt lgkmcnt(0)
L_b2:
    v_mov_b32 v120, 0
L_poll_32:
    ds_read_b32 v121, v120 offset:4688
    s_waitcnt lgkmcnt(0)
    v_cmp_gt_u32 vcc, 1, v121
    s_cbranch_vccz L_pdone_33
    s_cmp_eq_u32 s88, 0
    s_cbranch_scc1 L_pdone_33
    s_sub_u32 s88, s88, 1
    s_sleep 4
    s_branch L_poll_32
L_pdone_33:
    s_cmp_lt_u32 s89, 112
    s_cbranch_scc1 L_b3
    s_cmp_lt_u32 s89, 176
    s_cbranch_scc1 L_prep_wo
    s_cmp_ge_u32 s89, 240
    s_cbranch_scc1 L_prep_dn
    s_cmp_lt_u32 s89, 192
    s_cbranch_scc1 L_b3
    s_cmp_lt_u32 s89, 235
    s_cbranch_scc1 L_prep_up
    s_branch L_b3
L_prep_wo:
    s_sub_u32 s59, s89, 112
    s_and_b32 s68, s59, 7
    s_lshr_b32 s59, s59, 3
    s_min_u32 s69, s68, 0
    s_mul_i32 s68, s68, 8
    s_add_u32 s59, s59, s68
    s_add_u32 s59, s59, s69
    s_mov_b32 s8, s30
    s_mov_b32 s9, s31
    s_mov_b32 s10, 4194304
    s_mov_b32 s11, 0x20000
    s_lshr_b32 s56, s59, 3
    s_lshl_b32 s56, s56, 19
    s_and_b32 s57, s59, 7
    s_lshl_b32 s57, s57, 7
    s_add_u32 s56, s56, s57
    s_lshl_b32 s54, s3, 7
    v_lshrrev_b32 v11, 3, v2
    v_add_u32 v11, s54, v11
    s_mov_b32 s55, 1024
    v_mul_lo_u32 v11, v11, s55
    v_and_b32 v120, 7, v2
    v_lshl_add_u32 v11, v120, 4, v11
    v_add_u32 v11, s56, v11
    s_lshl_b32 s57, s3, 14
    s_mov_b32 s70, 0
    s_add_u32 s71, s57, 21760
    s_mov_b32 m0, s71
    s_add_u32 s71, s71, 1024
    buffer_load_dwordx4 v11, s[8:11], s70 offen nt lds
    s_add_u32 s70, s70, 8192
    s_mov_b32 m0, s71
    s_add_u32 s71, s71, 1024
    buffer_load_dwordx4 v11, s[8:11], s70 offen nt lds
    s_add_u32 s70, s70, 8192
    s_mov_b32 m0, s71
    s_add_u32 s71, s71, 1024
    buffer_load_dwordx4 v11, s[8:11], s70 offen nt lds
    s_add_u32 s70, s70, 8192
    s_mov_b32 m0, s71
    s_add_u32 s71, s71, 1024
    buffer_load_dwordx4 v11, s[8:11], s70 offen nt lds
    s_add_u32 s70, s70, 8192
    s_mov_b32 m0, s71
    s_add_u32 s71, s71, 1024
    buffer_load_dwordx4 v11, s[8:11], s70 offen nt lds
    s_add_u32 s70, s70, 8192
    s_mov_b32 m0, s71
    s_add_u32 s71, s71, 1024
    buffer_load_dwordx4 v11, s[8:11], s70 offen nt lds
    s_add_u32 s70, s70, 8192
    s_mov_b32 m0, s71
    s_add_u32 s71, s71, 1024
    buffer_load_dwordx4 v11, s[8:11], s70 offen nt lds
    s_add_u32 s70, s70, 8192
    s_mov_b32 m0, s71
    s_add_u32 s71, s71, 1024
    buffer_load_dwordx4 v11, s[8:11], s70 offen nt lds
    s_add_u32 s70, s70, 8192
    s_mov_b32 m0, s71
    s_add_u32 s71, s71, 1024
    buffer_load_dwordx4 v11, s[8:11], s70 offen nt lds
    s_add_u32 s70, s70, 8192
    s_mov_b32 m0, s71
    s_add_u32 s71, s71, 1024
    buffer_load_dwordx4 v11, s[8:11], s70 offen nt lds
    s_add_u32 s70, s70, 8192
    s_mov_b32 m0, s71
    s_add_u32 s71, s71, 1024
    buffer_load_dwordx4 v11, s[8:11], s70 offen nt lds
    s_add_u32 s70, s70, 8192
    s_mov_b32 m0, s71
    s_add_u32 s71, s71, 1024
    buffer_load_dwordx4 v11, s[8:11], s70 offen nt lds
    s_add_u32 s70, s70, 8192
    s_mov_b32 m0, s71
    s_add_u32 s71, s71, 1024
    buffer_load_dwordx4 v11, s[8:11], s70 offen nt lds
    s_add_u32 s70, s70, 8192
    s_mov_b32 m0, s71
    s_add_u32 s71, s71, 1024
    buffer_load_dwordx4 v11, s[8:11], s70 offen nt lds
    s_add_u32 s70, s70, 8192
    s_mov_b32 m0, s71
    s_add_u32 s71, s71, 1024
    buffer_load_dwordx4 v11, s[8:11], s70 offen nt lds
    s_add_u32 s70, s70, 8192
    s_mov_b32 m0, s71
    s_add_u32 s71, s71, 1024
    buffer_load_dwordx4 v11, s[8:11], s70 offen nt lds
    s_add_u32 s70, s70, 8192
    v_lshrrev_b32 v10, 2, v6
    v_lshl_add_u32 v10, v5, 3, v10
    v_lshlrev_b32 v10, 7, v10
    v_and_b32 v120, 3, v6
    v_lshl_add_u32 v10, v120, 3, v10
    s_lshl_b32 s54, s3, 14
    s_add_u32 s54, s54, 21760
    v_add_u32 v10, s54, v10
L_poll_34:
    buffer_load_dwordx4 v[120:123], off, s[76:79], 0 offset:128 sc1
    s_waitcnt vmcnt(0)
    v_add_u32 v120, v120, v121
    v_add3_u32 v120, v120, v122, v123
    v_cmp_gt_u32 vcc, 256, v120
    s_cbranch_vccz L_pdone_35
    s_cmp_eq_u32 s88, 0
    s_cbranch_scc1 L_pdone_35
    s_sub_u32 s88, s88, 1
    s_sleep 16
    s_branch L_poll_34
L_pdone_35:
    ds_read_b64_tr_b16 v[40:41], v10 offset:0
    ds_read_b64_tr_b16 v[42:43], v10 offset:512
    ds_read_b64_tr_b16 v[44:45], v10 offset:32
    ds_read_b64_tr_b16 v[46:47], v10 offset:544
    ds_read_b64_tr_b16 v[48:49], v10 offset:64
    ds_read_b64_tr_b16 v[50:51], v10 offset:576
    ds_read_b64_tr_b16 v[52:53], v10 offset:96
    ds_read_b64_tr_b16 v[54:55], v10 offset:608
    ds_read_b64_tr_b16 v[56:57], v10 offset:4096
    ds_read_b64_tr_b16 v[58:59], v10 offset:4608
    ds_read_b64_tr_b16 v[60:61], v10 offset:4128
    ds_read_b64_tr_b16 v[62:63], v10 offset:4640
    ds_read_b64_tr_b16 v[64:65], v10 offset:4160
    ds_read_b64_tr_b16 v[66:67], v10 offset:4672
    ds_read_b64_tr_b16 v[68:69], v10 offset:4192
    ds_read_b64_tr_b16 v[70:71], v10 offset:4704
    ds_read_b64_tr_b16 v[72:73], v10 offset:8192
    ds_read_b64_tr_b16 v[74:75], v10 offset:8704
    ds_read_b64_tr_b16 v[76:77], v10 offset:8224
    ds_read_b64_tr_b16 v[78:79], v10 offset:8736
    ds_read_b64_tr_b16 v[80:81], v10 offset:8256
    ds_read_b64_tr_b16 v[82:83], v10 offset:8768
    ds_read_b64_tr_b16 v[84:85], v10 offset:8288
    ds_read_b64_tr_b16 v[86:87], v10 offset:8800
    ds_read_b64_tr_b16 v[88:89], v10 offset:12288
    ds_read_b64_tr_b16 v[90:91], v10 offset:12800
    ds_read_b64_tr_b16 v[92:93], v10 offset:12320
    ds_read_b64_tr_b16 v[94:95], v10 offset:12832
    ds_read_b64_tr_b16 v[96:97], v10 offset:12352
    ds_read_b64_tr_b16 v[98:99], v10 offset:12864
    ds_read_b64_tr_b16 v[100:101], v10 offset:12384
    ds_read_b64_tr_b16 v[102:103], v10 offset:12896
    v_lshlrev_b32 v11, 18, v3
    v_lshl_add_u32 v12, v4, 4, v11
    v_and_b32 v120, 3, v2
    v_lshl_add_u32 v11, v120, 10, v11
    s_lshr_b32 s56, s59, 3
    s_lshl_b32 s60, s56, 12
    s_lshl_b32 s56, s56, 2
    s_add_u32 s56, s56, s3
    s_lshl_b32 s56, s56, 13
    s_add_u32 s56, s56, 65536
    s_add_u32 s55, s56, 4096
    s_and_b32 s57, s59, 7
    s_lshl_b32 s57, s57, 8
    s_add_u32 s60, s60, s57
    s_add_u32 s60, s60, 589824
    s_waitcnt lgkmcnt(0)
    s_branch L_b3
L_prep_up:
    s_sub_u32 s59, s89, 192
    s_and_b32 s68, s59, 7
    s_lshr_b32 s59, s59, 3
    s_min_u32 s69, s68, 3
    s_mul_i32 s68, s68, 5
    s_add_u32 s59, s59, s68
    s_add_u32 s59, s59, s69
    s_mov_b32 s8, s32
    s_mov_b32 s9, s33
    s_mov_b32 s10, 1409024
    s_mov_b32 s11, 0x20000
    s_mov_b32 s12, s34
    s_mov_b32 s13, s35
    s_mov_b32 s14, 1409024
    s_mov_b32 s15, 0x20000
    s_lshl_b32 s56, s59, 6
    s_mul_i32 s54, s3, 128
    v_lshrrev_b32 v11, 2, v2
    v_add_u32 v11, s54, v11
    s_mov_b32 s55, 2752
    v_mul_lo_u32 v11, v11, s55
    v_and_b32 v10, 3, v2
    v_lshl_add_u32 v11, v10, 4, v11
    v_add_u32 v11, s56, v11
    s_lshl_b32 s57, s3, 13
    s_mov_b32 s70, 0
    s_add_u32 s71, s57, 21760
    s_mov_b32 m0, s71
    s_add_u32 s71, s71, 1024
    buffer_load_dwordx4 v11, s[8:11], s70 offen nt lds
    s_add_u32 s70, s70, 44032
    s_mov_b32 m0, s71
    s_add_u32 s71, s71, 1024
    buffer_load_dwordx4 v11, s[8:11], s70 offen nt lds
    s_add_u32 s70, s70, 44032
    s_mov_b32 m0, s71
    s_add_u32 s71, s71, 1024
    buffer_load_dwordx4 v11, s[8:11], s70 offen nt lds
    s_add_u32 s70, s70, 44032
    s_mov_b32 m0, s71
    s_add_u32 s71, s71, 1024
    buffer_load_dwordx4 v11, s[8:11], s70 offen nt lds
    s_add_u32 s70, s70, 44032
    s_mov_b32 m0, s71
    s_add_u32 s71, s71, 1024
    buffer_load_dwordx4 v11, s[8:11], s70 offen nt lds
    s_add_u32 s70, s70, 44032
    s_mov_b32 m0, s71
    s_add_u32 s71, s71, 1024
    buffer_load_dwordx4 v11, s[8:11], s70 offen nt lds
    s_add_u32 s70, s70, 44032
    s_mov_b32 m0, s71
    s_add_u32 s71, s71, 1024
    buffer_load_dwordx4 v11, s[8:11], s70 offen nt lds
    s_add_u32 s70, s70, 44032
    s_mov_b32 m0, s71
    s_add_u32 s71, s71, 1024
    buffer_load_dwordx4 v11, s[8:11], s70 offen nt lds
    s_add_u32 s70, s70, 44032
    s_add_u32 s57, s57, 32768
    s_mov_b32 s70, 0
    s_add_u32 s71, s57, 21760
    s_mov_b32 m0, s71
    s_add_u32 s71, s71, 1024
    buffer_load_dwordx4 v11, s[12:15], s70 offen nt lds
    s_add_u32 s70, s70, 44032
    s_mov_b32 m0, s71
    s_add_u32 s71, s71, 1024
    buffer_load_dwordx4 v11, s[12:15], s70 offen nt lds
    s_add_u32 s70, s70, 44032
    s_mov_b32 m0, s71
    s_add_u32 s71, s71, 1024
    buffer_load_dwordx4 v11, s[12:15], s70 offen nt lds
    s_add_u32 s70, s70, 44032
    s_mov_b32 m0, s71
    s_add_u32 s71, s71, 1024
    buffer_load_dwordx4 v11, s[12:15], s70 offen nt lds
    s_add_u32 s70, s70, 44032
    s_mov_b32 m0, s71
    s_add_u32 s71, s71, 1024
    buffer_load_dwordx4 v11, s[12:15], s70 offen nt lds
    s_add_u32 s70, s70, 44032
    s_mov_b32 m0, s71
    s_add_u32 s71, s71, 1024
    buffer_load_dwordx4 v11, s[12:15], s70 offen nt lds
    s_add_u32 s70, s70, 44032
    s_mov_b32 m0, s71
    s_add_u32 s71, s71, 1024
    buffer_load_dwordx4 v11, s[12:15], s70 offen nt lds
    s_add_u32 s70, s70, 44032
    s_mov_b32 m0, s71
    s_add_u32 s71, s71, 1024
    buffer_load_dwordx4 v11, s[12:15], s70 offen nt lds
    s_add_u32 s70, s70, 44032
    v_lshrrev_b32 v10, 2, v6
    v_lshl_add_u32 v10, v5, 3, v10
    v_lshlrev_b32 v10, 6, v10
    v_and_b32 v12, 3, v6
    v_lshl_add_u32 v10, v12, 3, v10
    s_mul_i32 s54, s3, 8192
    s_add_u32 s54, s54, 21760
    v_add_u32 v10, s54, v10
    v_lshlrev_b32 v120, 10, v3
    v_lshl_add_u32 v120, v4, 3, v120
    s_lshl_b32 s54, s3, 8
    buffer_load_dwordx2 v[122:123], v120, s[20:23], s54 offen
    v_lshlrev_b32 v120, 11, v3
    v_lshl_add_u32 v120, v4, 4, v120
    s_lshl_b32 s54, s3, 9
    s_add_u32 s54, s54, 8192
    s_add_u32 s55, s54, 4096
    s_add_u32 s56, s54, 8192
L_poll_36:
    buffer_load_dwordx4 v[124:127], v120, s[84:87], s54 offen sc1
    buffer_load_dwordx4 v[128:131], v120, s[84:87], s55 offen sc1
    buffer_load_dwordx4 v[132:135], v120, s[84:87], s56 offen sc1
    s_waitcnt vmcnt(0)
    v_xor_b32 v136, s80, v125
    v_xor_b32 v137, s80, v127
    v_or_b32 v136, v136, v137
    v_xor_b32 v137, s80, v129
    v_or_b32 v136, v136, v137
    v_xor_b32 v137, s80, v131
    v_or_b32 v136, v136, v137
    v_xor_b32 v137, s80, v133
    v_or_b32 v136, v136, v137
    v_xor_b32 v137, s80, v135
    v_or_b32 v136, v136, v137
    v_cmp_ne_u32 vcc, 0, v136
    s_cbranch_vccz L_pdone_37
    s_cmp_eq_u32 s88, 0
    s_cbranch_scc1 L_pdone_37
    s_sub_u32 s88, s88, 1
    s_sleep 1
    s_branch L_poll_36
L_pdone_37:
    v_lshlrev_b32 v148, 16, v122
    v_and_b32 v149, 0xffff0000, v122
    v_lshlrev_b32 v150, 16, v123
    v_and_b32 v151, 0xffff0000, v123
    v_lshlrev_b32 v152, 16, v124
    v_and_b32 v153, 0xffff0000, v124
    v_lshlrev_b32 v154, 16, v126
    v_and_b32 v155, 0xffff0000, v126
    v_mov_b32 v160, v128
    v_mov_b32 v161, v130
    v_lshlrev_b32 v156, 16, v132
    v_and_b32 v157, 0xffff0000, v132
    v_lshlrev_b32 v158, 16, v134
    v_and_b32 v159, 0xffff0000, v134
    v_add_f32 v156, 1.0, v156
    v_add_f32 v157, 1.0, v157
    v_add_f32 v158, 1.0, v158
    v_add_f32 v159, 1.0, v159
    v_cvt_pk_bf16_f32 v121, v156, v157
    v_lshlrev_b32 v156, 16, v121
    v_and_b32 v157, 0xffff0000, v121
    v_cvt_pk_bf16_f32 v121, v158, v159
    v_lshlrev_b32 v158, 16, v121
    v_and_b32 v159, 0xffff0000, v121
L_poll_38:
    buffer_load_dwordx4 v[120:123], off, s[76:79], 0 offset:128 sc1
    s_waitcnt vmcnt(0)
    v_add_u32 v120, v120, v121
    v_add3_u32 v120, v120, v122, v123
    v_cmp_gt_u32 vcc, 256, v120
    s_cbranch_vccz L_pdone_39
    s_cmp_eq_u32 s88, 0
    s_cbranch_scc1 L_pdone_39
    s_sub_u32 s88, s88, 1
    s_sleep 16
    s_branch L_poll_38
L_pdone_39:
    ds_read_b64_tr_b16 v[40:41], v10 offset:0
    ds_read_b64_tr_b16 v[42:43], v10 offset:256
    ds_read_b64_tr_b16 v[44:45], v10 offset:32
    ds_read_b64_tr_b16 v[46:47], v10 offset:288
    ds_read_b64_tr_b16 v[48:49], v10 offset:32768
    ds_read_b64_tr_b16 v[50:51], v10 offset:33024
    ds_read_b64_tr_b16 v[52:53], v10 offset:32800
    ds_read_b64_tr_b16 v[54:55], v10 offset:33056
    ds_read_b64_tr_b16 v[56:57], v10 offset:2048
    ds_read_b64_tr_b16 v[58:59], v10 offset:2304
    ds_read_b64_tr_b16 v[60:61], v10 offset:2080
    ds_read_b64_tr_b16 v[62:63], v10 offset:2336
    ds_read_b64_tr_b16 v[64:65], v10 offset:34816
    ds_read_b64_tr_b16 v[66:67], v10 offset:35072
    ds_read_b64_tr_b16 v[68:69], v10 offset:34848
    ds_read_b64_tr_b16 v[70:71], v10 offset:35104
    ds_read_b64_tr_b16 v[72:73], v10 offset:4096
    ds_read_b64_tr_b16 v[74:75], v10 offset:4352
    ds_read_b64_tr_b16 v[76:77], v10 offset:4128
    ds_read_b64_tr_b16 v[78:79], v10 offset:4384
    ds_read_b64_tr_b16 v[80:81], v10 offset:36864
    ds_read_b64_tr_b16 v[82:83], v10 offset:37120
    ds_read_b64_tr_b16 v[84:85], v10 offset:36896
    ds_read_b64_tr_b16 v[86:87], v10 offset:37152
    ds_read_b64_tr_b16 v[88:89], v10 offset:6144
    ds_read_b64_tr_b16 v[90:91], v10 offset:6400
    ds_read_b64_tr_b16 v[92:93], v10 offset:6176
    ds_read_b64_tr_b16 v[94:95], v10 offset:6432
    ds_read_b64_tr_b16 v[96:97], v10 offset:38912
    ds_read_b64_tr_b16 v[98:99], v10 offset:39168
    ds_read_b64_tr_b16 v[100:101], v10 offset:38944
    ds_read_b64_tr_b16 v[102:103], v10 offset:39200
    v_lshlrev_b32 v12, 11, v3
    v_lshl_add_u32 v12, v4, 4, v12
    s_lshl_b32 s56, s3, 9
    s_add_u32 s56, s56, 589824
    s_lshl_b32 s60, s59, 7
    s_add_u32 s60, s60, 622592
    s_waitcnt lgkmcnt(0)
    s_branch L_b3
L_prep_dn:
    s_sub_u32 s59, s89, 240
    s_and_b32 s68, s59, 7
    s_lshr_b32 s59, s59, 3
    s_min_u32 s69, s68, 0
    s_mul_i32 s68, s68, 2
    s_add_u32 s59, s59, s68
    s_add_u32 s59, s59, s69
    s_mov_b32 s8, s36
    s_mov_b32 s9, s37
    s_mov_b32 s10, 1409024
    s_mov_b32 s11, 0x20000
    s_lshl_b32 s56, s59, 6
    s_mul_i32 s54, s3, 352
    v_lshrrev_b32 v11, 2, v2
    v_add_u32 v11, s54, v11
    s_mov_b32 s55, 1024
    v_mul_lo_u32 v11, v11, s55
    v_and_b32 v10, 3, v2
    v_lshl_add_u32 v11, v10, 4, v11
    v_add_u32 v11, s56, v11
    s_mul_i32 s57, s3, 22528
    s_mov_b32 s70, 0
    s_add_u32 s71, s57, 21760
    s_mov_b32 m0, s71
    s_add_u32 s71, s71, 1024
    buffer_load_dwordx4 v11, s[8:11], s70 offen nt lds
    s_add_u32 s70, s70, 16384
    s_mov_b32 m0, s71
    s_add_u32 s71, s71, 1024
    buffer_load_dwordx4 v11, s[8:11], s70 offen nt lds
    s_add_u32 s70, s70, 16384
    s_mov_b32 m0, s71
    s_add_u32 s71, s71, 1024
    buffer_load_dwordx4 v11, s[8:11], s70 offen nt lds
    s_add_u32 s70, s70, 16384
    s_mov_b32 m0, s71
    s_add_u32 s71, s71, 1024
    buffer_load_dwordx4 v11, s[8:11], s70 offen nt lds
    s_add_u32 s70, s70, 16384
    s_mov_b32 m0, s71
    s_add_u32 s71, s71, 1024
    buffer_load_dwordx4 v11, s[8:11], s70 offen nt lds
    s_add_u32 s70, s70, 16384
    s_mov_b32 m0, s71
    s_add_u32 s71, s71, 1024
    buffer_load_dwordx4 v11, s[8:11], s70 offen nt lds
    s_add_u32 s70, s70, 16384
    s_mov_b32 m0, s71
    s_add_u32 s71, s71, 1024
    buffer_load_dwordx4 v11, s[8:11], s70 offen nt lds
    s_add_u32 s70, s70, 16384
    s_mov_b32 m0, s71
    s_add_u32 s71, s71, 1024
    buffer_load_dwordx4 v11, s[8:11], s70 offen nt lds
    s_add_u32 s70, s70, 16384
    s_mov_b32 m0, s71
    s_add_u32 s71, s71, 1024
    buffer_load_dwordx4 v11, s[8:11], s70 offen nt lds
    s_add_u32 s70, s70, 16384
    s_mov_b32 m0, s71
    s_add_u32 s71, s71, 1024
    buffer_load_dwordx4 v11, s[8:11], s70 offen nt lds
    s_add_u32 s70, s70, 16384
    s_mov_b32 m0, s71
    s_add_u32 s71, s71, 1024
    buffer_load_dwordx4 v11, s[8:11], s70 offen nt lds
    s_add_u32 s70, s70, 16384
    s_mov_b32 m0, s71
    s_add_u32 s71, s71, 1024
    buffer_load_dwordx4 v11, s[8:11], s70 offen nt lds
    s_add_u32 s70, s70, 16384
    s_mov_b32 m0, s71
    s_add_u32 s71, s71, 1024
    buffer_load_dwordx4 v11, s[8:11], s70 offen nt lds
    s_add_u32 s70, s70, 16384
    s_mov_b32 m0, s71
    s_add_u32 s71, s71, 1024
    buffer_load_dwordx4 v11, s[8:11], s70 offen nt lds
    s_add_u32 s70, s70, 16384
    s_mov_b32 m0, s71
    s_add_u32 s71, s71, 1024
    buffer_load_dwordx4 v11, s[8:11], s70 offen nt lds
    s_add_u32 s70, s70, 16384
    s_mov_b32 m0, s71
    s_add_u32 s71, s71, 1024
    buffer_load_dwordx4 v11, s[8:11], s70 offen nt lds
    s_add_u32 s70, s70, 16384
    s_mov_b32 m0, s71
    s_add_u32 s71, s71, 1024
    buffer_load_dwordx4 v11, s[8:11], s70 offen nt lds
    s_add_u32 s70, s70, 16384
    s_mov_b32 m0, s71
    s_add_u32 s71, s71, 1024
    buffer_load_dwordx4 v11, s[8:11], s70 offen nt lds
    s_add_u32 s70, s70, 16384
    s_mov_b32 m0, s71
    s_add_u32 s71, s71, 1024
    buffer_load_dwordx4 v11, s[8:11], s70 offen nt lds
    s_add_u32 s70, s70, 16384
    s_mov_b32 m0, s71
    s_add_u32 s71, s71, 1024
    buffer_load_dwordx4 v11, s[8:11], s70 offen nt lds
    s_add_u32 s70, s70, 16384
    s_mov_b32 m0, s71
    s_add_u32 s71, s71, 1024
    buffer_load_dwordx4 v11, s[8:11], s70 offen nt lds
    s_add_u32 s70, s70, 16384
    s_mov_b32 m0, s71
    s_add_u32 s71, s71, 1024
    buffer_load_dwordx4 v11, s[8:11], s70 offen nt lds
    s_add_u32 s70, s70, 16384
    v_lshrrev_b32 v10, 2, v6
    v_lshl_add_u32 v10, v5, 3, v10
    v_lshlrev_b32 v10, 6, v10
    v_and_b32 v12, 3, v6
    v_lshl_add_u32 v10, v12, 3, v10
    s_mul_i32 s54, s3, 22528
    s_add_u32 s54, s54, 21760
    v_add_u32 v10, s54, v10
    v_lshrrev_b32 v13, 3, v2
    v_and_b32 v13, 1, v13
    v_and_b32 v14, 7, v2
    v_lshlrev_b32 v15, 10, v13
    v_lshl_add_u32 v15, v14, 3, v15
    buffer_load_dwordx2 v[16:17], v15, s[20:23], s56 offen
    v_lshlrev_b32 v15, 11, v13
    v_lshl_add_u32 v15, v14, 4, v15
    s_lshl_b32 s54, s59, 7
    s_add_u32 s55, s54, 20480
    s_add_u32 s54, s54, 8192
L_poll_40:
    buffer_load_dwordx4 v[120:123], v15, s[84:87], s54 offen sc1
    buffer_load_dwordx4 v[124:127], v15, s[84:87], s55 offen sc1
    s_waitcnt vmcnt(0)
    v_xor_b32 v128, s80, v121
    v_xor_b32 v129, s80, v123
    v_or_b32 v128, v128, v129
    v_xor_b32 v129, s80, v125
    v_or_b32 v128, v128, v129
    v_xor_b32 v129, s80, v127
    v_or_b32 v128, v128, v129
    v_cmp_ne_u32 vcc, 0, v128
    s_cbranch_vccz L_pdone_41
    s_cmp_eq_u32 s88, 0
    s_cbranch_scc1 L_pdone_41
    s_sub_u32 s88, s88, 1
    s_sleep 1
    s_branch L_poll_40
L_pdone_41:
    v_mov_b32 v18, v120
    v_mov_b32 v19, v122
    v_mov_b32 v20, v124
    v_mov_b32 v21, v126
L_poll_42:
    buffer_load_dwordx4 v[120:123], off, s[76:79], 0 offset:128 sc1
    s_waitcnt vmcnt(0)
    v_add_u32 v120, v120, v121
    v_add3_u32 v120, v120, v122, v123
    v_cmp_gt_u32 vcc, 256, v120
    s_cbranch_vccz L_pdone_43
    s_cmp_eq_u32 s88, 0
    s_cbranch_scc1 L_pdone_43
    s_sub_u32 s88, s88, 1
    s_sleep 16
    s_branch L_poll_42
L_pdone_43:
    ds_read_b64_tr_b16 v[32:33], v10 offset:0
    ds_read_b64_tr_b16 v[34:35], v10 offset:256
    ds_read_b64_tr_b16 v[36:37], v10 offset:32
    ds_read_b64_tr_b16 v[38:39], v10 offset:288
    ds_read_b64_tr_b16 v[40:41], v10 offset:2048
    ds_read_b64_tr_b16 v[42:43], v10 offset:2304
    ds_read_b64_tr_b16 v[44:45], v10 offset:2080
    ds_read_b64_tr_b16 v[46:47], v10 offset:2336
    ds_read_b64_tr_b16 v[48:49], v10 offset:4096
    ds_read_b64_tr_b16 v[50:51], v10 offset:4352
    ds_read_b64_tr_b16 v[52:53], v10 offset:4128
    ds_read_b64_tr_b16 v[54:55], v10 offset:4384
    ds_read_b64_tr_b16 v[56:57], v10 offset:6144
    ds_read_b64_tr_b16 v[58:59], v10 offset:6400
    ds_read_b64_tr_b16 v[60:61], v10 offset:6176
    ds_read_b64_tr_b16 v[62:63], v10 offset:6432
    ds_read_b64_tr_b16 v[64:65], v10 offset:8192
    ds_read_b64_tr_b16 v[66:67], v10 offset:8448
    ds_read_b64_tr_b16 v[68:69], v10 offset:8224
    ds_read_b64_tr_b16 v[70:71], v10 offset:8480
    ds_read_b64_tr_b16 v[72:73], v10 offset:10240
    ds_read_b64_tr_b16 v[74:75], v10 offset:10496
    ds_read_b64_tr_b16 v[76:77], v10 offset:10272
    ds_read_b64_tr_b16 v[78:79], v10 offset:10528
    ds_read_b64_tr_b16 v[80:81], v10 offset:12288
    ds_read_b64_tr_b16 v[82:83], v10 offset:12544
    ds_read_b64_tr_b16 v[84:85], v10 offset:12320
    ds_read_b64_tr_b16 v[86:87], v10 offset:12576
    ds_read_b64_tr_b16 v[88:89], v10 offset:14336
    ds_read_b64_tr_b16 v[90:91], v10 offset:14592
    ds_read_b64_tr_b16 v[92:93], v10 offset:14368
    ds_read_b64_tr_b16 v[94:95], v10 offset:14624
    ds_read_b64_tr_b16 v[96:97], v10 offset:16384
    ds_read_b64_tr_b16 v[98:99], v10 offset:16640
    ds_read_b64_tr_b16 v[100:101], v10 offset:16416
    ds_read_b64_tr_b16 v[102:103], v10 offset:16672
    ds_read_b64_tr_b16 v[104:105], v10 offset:18432
    ds_read_b64_tr_b16 v[106:107], v10 offset:18688
    ds_read_b64_tr_b16 v[108:109], v10 offset:18464
    ds_read_b64_tr_b16 v[110:111], v10 offset:18720
    ds_read_b64_tr_b16 v[112:113], v10 offset:20480
    ds_read_b64_tr_b16 v[114:115], v10 offset:20736
    ds_read_b64_tr_b16 v[116:117], v10 offset:20512
    ds_read_b64_tr_b16 v[118:119], v10 offset:20768
    s_lshl_b32 s56, s59, 7
    s_add_u32 s56, s56, 589824
    v_and_b32 v12, 1, v2
    v_lshlrev_b32 v12, 6, v12
    v_lshl_add_u32 v12, v5, 4, v12
    s_mul_i32 s57, s3, 22528
    s_add_u32 s57, s57, 21760
    v_add_u32 v12, s57, v12
    v_lshlrev_b32 v7, 4, v2
    v_add_u32 v8, s57, v7
    s_mul_i32 s57, s3, 1408
    s_waitcnt lgkmcnt(0)
L_b3:
    s_cmp_eq_u32 s3, 2
    s_cbranch_scc0 L_b3x
    s_setprio 1
    s_mul_i32 s65, s45, 4224
    s_add_u32 s65, s65, 1048576
    s_add_u32 s26, s98, s65
    s_addc_u32 s27, s99, 0
    v_mov_b32 v22, 0
L_poll_44:
    ds_read_b32 v23, v22 offset:4692
    s_waitcnt lgkmcnt(0)
    v_cmp_eq_u32 vcc, 0, v23
    s_cbranch_vccz L_pdone_45
    s_cmp_eq_u32 s88, 0
    s_cbranch_scc1 L_pdone_45
    s_sub_u32 s88, s88, 1
    s_sleep 8
    s_branch L_poll_44
L_pdone_45:
    s_mov_b32 s64, 0
L_disp:
    ds_read_b32 v23, v22 offset:4704
    s_waitcnt lgkmcnt(0)
    v_readfirstlane_b32 s65, v23
    s_cmp_lt_u32 s64, s65
    s_cbranch_scc1 L_disp_go
    s_cmp_eq_u32 s88, 0
    s_cbranch_scc1 L_disp_end
    s_sub_u32 s88, s88, 1
    s_sleep 1
    s_branch L_disp
L_disp_go:
    s_mov_b32 s66, 1
    s_atomic_add s66, s[26:27], 0 glc
    s_lshl_b32 s65, s64, 2
    v_mov_b32 v24, s65
    s_waitcnt lgkmcnt(0)
    s_cmp_ge_u32 s66, 64
    s_cbranch_scc1 L_disp_end
    s_add_u32 s66, s66, 1
    v_mov_b32 v23, s66
    ds_write_b32 v24, v23 offset:4928
    s_add_u32 s64, s64, 1
    s_cmp_lt_u32 s64, 63
    s_cbranch_scc1 L_disp
L_disp_end:
    v_lshlrev_b32 v24, 2, v2
    v_mov_b32 v23, 65
    v_cmp_le_u32 vcc, s64, v2
    s_mov_b64 exec, vcc
    ds_write_b32 v24, v23 offset:4928
    s_mov_b64 exec, -1
    s_setprio 2
L_b3x:
    s_barrier
L_after_b3:
    s_cmp_lt_u32 s3, 1
    s_cbranch_scc0 L_tail
    v_and_b32 v120, 7, v2
    v_lshlrev_b32 v120, 3, v120
    s_lshl_b32 s63, s3, 6
    v_add_u32 v120, s63, v120
    ds_read_b64 v[122:123], v120 offset:5184
    v_lshlrev_b32 v121, 3, v2
    s_lshl_b32 s63, s3, 13
    v_add_u32 v127, s63, v121
    ds_read_b64 v[128:129], v127 offset:5376
    ds_read_b64 v[130:131], v127 offset:6400
    ds_read_b64 v[132:133], v127 offset:7424
    ds_read_b64 v[134:135], v127 offset:8448
    ds_read_b64 v[136:137], v127 offset:9472
    ds_read_b64 v[138:139], v127 offset:10496
    ds_read_b64 v[140:141], v127 offset:11520
    ds_read_b64 v[142:143], v127 offset:12544
    s_waitcnt lgkmcnt(8)
    v_max_f32_dpp v124, v122, v122 row_ror:1 row_mask:0xf bank_mask:0xf
    s_nop 1
    v_max_f32_dpp v124, v124, v124 row_ror:2 row_mask:0xf bank_mask:0xf
    s_nop 1
    v_max_f32_dpp v124, v124, v124 row_ror:4 row_mask:0xf bank_mask:0xf
    s_mov_b32 s58, 0x3fb8aa3b
    v_sub_f32 v126, v122, v124
    v_mul_f32 v126, s58, v126
    v_exp_f32 v126, v126
    s_nop 0
    v_mul_f32 v125, v126, v123
    s_nop 1
    v_add_f32_dpp v125, v125, v125 row_ror:1 row_mask:0xf bank_mask:0xf
    s_nop 1
    v_add_f32_dpp v125, v125, v125 row_ror:2 row_mask:0xf bank_mask:0xf
    s_nop 1
    v_add_f32_dpp v125, v125, v125 row_ror:4 row_mask:0xf bank_mask:0xf
    s_waitcnt lgkmcnt(0)
    v_mul_f32_dpp v144, v126, v128 row_newbcast:0 row_mask:0xf bank_mask:0xf
    v_mul_f32_dpp v145, v126, v129 row_newbcast:0 row_mask:0xf bank_mask:0xf
    v_fmac_f32_dpp v144, v126, v130 row_newbcast:1 row_mask:0xf bank_mask:0xf
    v_fmac_f32_dpp v145, v126, v131 row_newbcast:1 row_mask:0xf bank_mask:0xf
    v_fmac_f32_dpp v144, v126, v132 row_newbcast:2 row_mask:0xf bank_mask:0xf
    v_fmac_f32_dpp v145, v126, v133 row_newbcast:2 row_mask:0xf bank_mask:0xf
    v_fmac_f32_dpp v144, v126, v134 row_newbcast:3 row_mask:0xf bank_mask:0xf
    v_fmac_f32_dpp v145, v126, v135 row_newbcast:3 row_mask:0xf bank_mask:0xf
    v_fmac_f32_dpp v144, v126, v136 row_newbcast:4 row_mask:0xf bank_mask:0xf
    v_fmac_f32_dpp v145, v126, v137 row_newbcast:4 row_mask:0xf bank_mask:0xf
    v_fmac_f32_dpp v144, v126, v138 row_newbcast:5 row_mask:0xf bank_mask:0xf
    v_fmac_f32_dpp v145, v126, v139 row_newbcast:5 row_mask:0xf bank_mask:0xf
    v_fmac_f32_dpp v144, v126, v140 row_newbcast:6 row_mask:0xf bank_mask:0xf
    v_fmac_f32_dpp v145, v126, v141 row_newbcast:6 row_mask:0xf bank_mask:0xf
    v_fmac_f32_dpp v144, v126, v142 row_newbcast:7 row_mask:0xf bank_mask:0xf
    v_fmac_f32_dpp v145, v126, v143 row_newbcast:7 row_mask:0xf bank_mask:0xf
    v_min_u32 v144, -2, v144
    v_min_u32 v145, -2, v145
    v_min_u32 v124, -2, v124
    v_min_u32 v125, -2, v125
    s_cmp_eq_u32 s3, 0
    s_cselect_b32 s63, s83, s67
    v_mov_b32_dpp v146, v144 quad_perm:[1,1,3,3] row_mask:0xf bank_mask:0xf
    v_mov_b32_dpp v147, v145 quad_perm:[1,1,3,3] row_mask:0xf bank_mask:0xf
    s_mov_b32 exec_lo, 0x55555555
    s_mov_b32 exec_hi, 0x55555555
    buffer_store_dwordx4 v[144:147], v121, s[84:87], s63 offen sc1
    s_mov_b64 exec, 1
    buffer_store_dwordx2 v[124:125], off, s[84:87], s63 offset:512 sc1
    s_mov_b64 exec, -1
L_tail:
    s_cmp_lt_u32 s89, 112
    s_cbranch_scc1 L_end
    s_cmp_lt_u32 s89, 176
    s_cbranch_scc1 L_tail_wo
    s_cmp_ge_u32 s89, 240
    s_cbranch_scc1 L_tail_dn
    s_cmp_lt_u32 s89, 192
    s_cbranch_scc1 L_end
    s_cmp_lt_u32 s89, 235
    s_cbranch_scc1 L_tail_up
    s_branch L_end
L_tail_wo:
L_poll_46:
    buffer_load_dwordx4 v[24:27], v12, s[84:87], s56 offen offset:0 sc1
    buffer_load_dwordx4 v[28:31], v12, s[84:87], s56 offen offset:1024 sc1
    buffer_load_dwordx4 v[32:35], v12, s[84:87], s56 offen offset:2048 sc1
    buffer_load_dwordx4 v[36:39], v12, s[84:87], s56 offen offset:3072 sc1
    buffer_load_dwordx2 v[120:121], v11, s[84:87], s56 offen offset:512 sc1
    s_waitcnt vmcnt(0)
    v_max3_u32 v122, v24, v25, v26
    v_max3_u32 v122, v122, v27, v28
    v_max3_u32 v122, v122, v29, v30
    v_max3_u32 v122, v122, v31, v32
    v_max3_u32 v122, v122, v33, v34
    v_max3_u32 v122, v122, v35, v36
    v_max3_u32 v122, v122, v37, v38
    v_max3_u32 v122, v122, v39, v120
    v_max_u32 v122, v122, v121
    v_cmp_eq_u32 vcc, -1, v122
    s_cbranch_vccz L_pdone_47
    s_cmp_eq_u32 s88, 0
    s_cbranch_scc1 L_pdone_47
    s_sub_u32 s88, s88, 1
    s_sleep 1
    s_branch L_poll_46
L_pdone_47:
    v_max_f32_dpp v122, v120, v120 row_ror:1 row_mask:0xf bank_mask:0xf
    s_mov_b32 s58, 0x3fb8aa3b
    s_nop 0
    v_max_f32_dpp v122, v122, v122 row_ror:2 row_mask:0xf bank_mask:0xf
    v_sub_f32 v123, v120, v122
    v_mul_f32 v123, s58, v123
    v_exp_f32 v123, v123
    s_nop 0
    v_mul_f32 v126, v123, v121
    s_nop 0
    v_mul_f32_dpp v128, v123, v24 row_newbcast:0 row_mask:0xf bank_mask:0xf
    v_mul_f32_dpp v129, v123, v25 row_newbcast:0 row_mask:0xf bank_mask:0xf
    v_mul_f32_dpp v130, v123, v26 row_newbcast:0 row_mask:0xf bank_mask:0xf
    v_mul_f32_dpp v131, v123, v27 row_newbcast:0 row_mask:0xf bank_mask:0xf
    v_add_f32_dpp v126, v126, v126 row_ror:1 row_mask:0xf bank_mask:0xf
    v_fmac_f32_dpp v128, v123, v28 row_newbcast:1 row_mask:0xf bank_mask:0xf
    v_fmac_f32_dpp v129, v123, v29 row_newbcast:1 row_mask:0xf bank_mask:0xf
    v_fmac_f32_dpp v130, v123, v30 row_newbcast:1 row_mask:0xf bank_mask:0xf
    v_fmac_f32_dpp v131, v123, v31 row_newbcast:1 row_mask:0xf bank_mask:0xf
    v_add_f32_dpp v126, v126, v126 row_ror:2 row_mask:0xf bank_mask:0xf
    v_fmac_f32_dpp v128, v123, v32 row_newbcast:2 row_mask:0xf bank_mask:0xf
    v_fmac_f32_dpp v129, v123, v33 row_newbcast:2 row_mask:0xf bank_mask:0xf
    v_fmac_f32_dpp v130, v123, v34 row_newbcast:2 row_mask:0xf bank_mask:0xf
    v_fmac_f32_dpp v131, v123, v35 row_newbcast:2 row_mask:0xf bank_mask:0xf
    v_rcp_f32 v126, v126
    v_fmac_f32_dpp v128, v123, v36 row_newbcast:3 row_mask:0xf bank_mask:0xf
    v_fmac_f32_dpp v129, v123, v37 row_newbcast:3 row_mask:0xf bank_mask:0xf
    v_fmac_f32_dpp v130, v123, v38 row_newbcast:3 row_mask:0xf bank_mask:0xf
    v_fmac_f32_dpp v131, v123, v39 row_newbcast:3 row_mask:0xf bank_mask:0xf
    v_mul_f32 v128, v126, v128
    v_mul_f32 v129, v126, v129
    v_mul_f32 v130, v126, v130
    v_mul_f32 v131, v126, v131
    v_cvt_pk_bf16_f32 v124, v128, v129
    v_cvt_pk_bf16_f32 v125, v130, v131
    ds_write_b64 v7, v[124:125]
    ds_read_b128 v[24:27], v8 offset:0
    ds_read_b128 v[28:31], v8 offset:64
    ds_read_b128 v[32:35], v8 offset:128
    ds_read_b128 v[36:39], v8 offset:192
    s_waitcnt lgkmcnt(3)
    v_mfma_f32_16x16x32_bf16 v[104:107], v[24:27], v[40:43], 0
    v_mfma_f32_16x16x32_bf16 v[108:111], v[24:27], v[44:47], 0
    v_mfma_f32_16x16x32_bf16 v[112:115], v[24:27], v[48:51], 0
    v_mfma_f32_16x16x32_bf16 v[116:119], v[24:27], v[52:55], 0
    s_waitcnt lgkmcnt(2)
    v_mfma_f32_16x16x32_bf16 v[104:107], v[28:31], v[56:59], v[104:107]
    v_mfma_f32_16x16x32_bf16 v[108:111], v[28:31], v[60:63], v[108:111]
    v_mfma_f32_16x16x32_bf16 v[112:115], v[28:31], v[64:67], v[112:115]
    v_mfma_f32_16x16x32_bf16 v[116:119], v[28:31], v[68:71], v[116:119]
    s_waitcnt lgkmcnt(1)
    v_mfma_f32_16x16x32_bf16 v[104:107], v[32:35], v[72:75], v[104:107]
    v_mfma_f32_16x16x32_bf16 v[108:111], v[32:35], v[76:79], v[108:111]
    v_mfma_f32_16x16x32_bf16 v[112:115], v[32:35], v[80:83], v[112:115]
    v_mfma_f32_16x16x32_bf16 v[116:119], v[32:35], v[84:87], v[116:119]
    s_waitcnt lgkmcnt(0)
    v_mfma_f32_16x16x32_bf16 v[104:107], v[36:39], v[88:91], v[104:107]
    v_mfma_f32_16x16x32_bf16 v[108:111], v[36:39], v[92:95], v[108:111]
    v_mfma_f32_16x16x32_bf16 v[112:115], v[36:39], v[96:99], v[112:115]
    v_mfma_f32_16x16x32_bf16 v[116:119], v[36:39], v[100:103], v[116:119]
    s_nop 7
    v_mov_b32_dpp v120, v104 quad_perm:[0,1,2,3] row_mask:0x1 bank_mask:0xf
    v_mov_b32_dpp v121, v105 quad_perm:[0,1,2,3] row_mask:0x1 bank_mask:0xf
    v_mov_b32_dpp v120, v108 quad_perm:[0,1,2,3] row_mask:0x2 bank_mask:0xf
    v_mov_b32_dpp v121, v109 quad_perm:[0,1,2,3] row_mask:0x2 bank_mask:0xf
    v_mov_b32_dpp v120, v112 quad_perm:[0,1,2,3] row_mask:0x4 bank_mask:0xf
    v_mov_b32_dpp v121, v113 quad_perm:[0,1,2,3] row_mask:0x4 bank_mask:0xf
    v_mov_b32_dpp v120, v116 quad_perm:[0,1,2,3] row_mask:0x8 bank_mask:0xf
    v_mov_b32_dpp v121, v117 quad_perm:[0,1,2,3] row_mask:0x8 bank_mask:0xf
    ds_write_b32 v9, v120
    ds_write_b32 v9, v121 offset:256
    s_waitcnt lgkmcnt(0)
    s_barrier
    s_cmp_eq_u32 s3, 0
    s_cbranch_scc0 L_end
    v_and_b32 v120, 1, v5
    v_lshlrev_b32 v120, 8, v120
    v_lshl_add_u32 v120, v6, 4, v120
    ds_read_b128 v[124:127], v120 offset:2048
    ds_read_b128 v[128:131], v120 offset:2560
    ds_read_b128 v[132:135], v120 offset:3072
    ds_read_b128 v[136:139], v120 offset:3584
    s_waitcnt lgkmcnt(0)
    v_pk_add_f32 v[124:125], v[124:125], v[128:129]
    v_pk_add_f32 v[126:127], v[126:127], v[130:131]
    v_pk_add_f32 v[132:133], v[132:133], v[136:137]
    v_pk_add_f32 v[134:135], v[134:135], v[138:139]
    v_pk_add_f32 v[124:125], v[124:125], v[132:133]
    v_pk_add_f32 v[126:127], v[126:127], v[134:135]
    v_min_u32 v124, -2, v124
    v_min_u32 v125, -2, v125
    v_min_u32 v126, -2, v126
    v_min_u32 v127, -2, v127
    v_lshlrev_b32 v120, 11, v5
    v_lshl_add_u32 v120, v6, 4, v120
    s_mov_b32 exec_hi, 0
    buffer_store_dwordx4 v[124:127], v120, s[84:87], s60 offen sc1
    s_branch L_end
L_tail_up:
L_poll_48:
    s_add_u32 s57, s56, 0
    buffer_load_dwordx4 v[24:27], v12, s[84:87], s57 offen sc1
    s_add_u32 s57, s56, 4096
    buffer_load_dwordx4 v[28:31], v12, s[84:87], s57 offen sc1
    s_add_u32 s57, s56, 8192
    buffer_load_dwordx4 v[32:35], v12, s[84:87], s57 offen sc1
    s_add_u32 s57, s56, 12288
    buffer_load_dwordx4 v[36:39], v12, s[84:87], s57 offen sc1
    s_add_u32 s57, s56, 16384
    buffer_load_dwordx4 v[104:107], v12, s[84:87], s57 offen sc1
    s_add_u32 s57, s56, 20480
    buffer_load_dwordx4 v[108:111], v12, s[84:87], s57 offen sc1
    s_add_u32 s57, s56, 24576
    buffer_load_dwordx4 v[112:115], v12, s[84:87], s57 offen sc1
    s_add_u32 s57, s56, 28672
    buffer_load_dwordx4 v[116:119], v12, s[84:87], s57 offen sc1
    s_waitcnt vmcnt(0)
    v_max3_u32 v120, v24, v25, v26
    v_max3_u32 v120, v120, v27, v28
    v_max3_u32 v120, v120, v29, v30
    v_max3_u32 v120, v120, v31, v32
    v_max3_u32 v120, v120, v33, v34
    v_max3_u32 v120, v120, v35, v36
    v_max3_u32 v120, v120, v37, v38
    v_max3_u32 v120, v120, v39, v104
    v_max3_u32 v120, v120, v105, v106
    v_max3_u32 v120, v120, v107, v108
    v_max3_u32 v120, v120, v109, v110
    v_max3_u32 v120, v120, v111, v112
    v_max3_u32 v120, v120, v113, v114
    v_max3_u32 v120, v120, v115, v116
    v_max3_u32 v120, v120, v117, v118
    v_max_u32 v120, v120, v119
    v_cmp_eq_u32 vcc, -1, v120
    s_cbranch_vccz L_pdone_49
    s_cmp_eq_u32 s88, 0
    s_cbranch_scc1 L_pdone_49
    s_sub_u32 s88, s88, 1
    s_sleep 1
    s_branch L_poll_48
L_pdone_49:
    v_pk_add_f32 v[24:25], v[24:25], v[28:29]
    v_pk_add_f32 v[26:27], v[26:27], v[30:31]
    v_pk_add_f32 v[32:33], v[32:33], v[36:37]
    v_pk_add_f32 v[34:35], v[34:35], v[38:39]
    v_pk_add_f32 v[104:105], v[104:105], v[108:109]
    v_pk_add_f32 v[106:107], v[106:107], v[110:111]
    v_pk_add_f32 v[112:113], v[112:113], v[116:117]
    v_pk_add_f32 v[114:115], v[114:115], v[118:119]
    v_pk_add_f32 v[24:25], v[24:25], v[32:33]
    v_pk_add_f32 v[26:27], v[26:27], v[34:35]
    v_pk_add_f32 v[104:105], v[104:105], v[112:113]
    v_pk_add_f32 v[106:107], v[106:107], v[114:115]
    v_pk_add_f32 v[124:125], v[24:25], v[104:105]
    v_pk_add_f32 v[126:127], v[26:27], v[106:107]
    v_cvt_pk_bf16_f32 v120, v124, v125
    v_lshlrev_b32 v124, 16, v120
    v_and_b32 v125, 0xffff0000, v120
    v_cvt_pk_bf16_f32 v121, v126, v127
    v_lshlrev_b32 v126, 16, v121
    v_and_b32 v127, 0xffff0000, v121
    v_pk_mul_f32 v[124:125], v[124:125], v[152:153]
    v_pk_mul_f32 v[126:127], v[126:127], v[154:155]
    v_cvt_pk_bf16_f32 v120, v124, v125
    v_lshlrev_b32 v124, 16, v120
    v_and_b32 v125, 0xffff0000, v120
    v_cvt_pk_bf16_f32 v121, v126, v127
    v_lshlrev_b32 v126, 16, v121
    v_and_b32 v127, 0xffff0000, v121
    v_pk_add_f32 v[124:125], v[124:125], v[148:149]
    v_pk_add_f32 v[126:127], v[126:127], v[150:151]
    v_cvt_pk_bf16_f32 v120, v124, v125
    v_lshlrev_b32 v124, 16, v120
    v_and_b32 v125, 0xffff0000, v120
    v_cvt_pk_bf16_f32 v121, v126, v127
    v_lshlrev_b32 v126, 16, v121
    v_and_b32 v127, 0xffff0000, v121
    v_add_f32 v128, v124, v125
    v_mul_f32 v129, v124, v124
    v_add_f32 v130, v126, v127
    v_fmac_f32 v129, v125, v125
    v_add_f32 v128, v128, v130
    v_fmac_f32 v129, v126, v126
    v_fmac_f32 v129, v127, v127
    s_nop 0
    v_add_f32_dpp v128, v128, v128 row_ror:8 row_mask:0xf bank_mask:0xf
    v_add_f32_dpp v129, v129, v129 row_ror:8 row_mask:0xf bank_mask:0xf
    s_nop 0
    v_add_f32_dpp v128, v128, v128 row_ror:4 row_mask:0xf bank_mask:0xf
    v_add_f32_dpp v129, v129, v129 row_ror:4 row_mask:0xf bank_mask:0xf
    s_nop 0
    v_add_f32_dpp v128, v128, v128 row_ror:2 row_mask:0xf bank_mask:0xf
    v_add_f32_dpp v129, v129, v129 row_ror:2 row_mask:0xf bank_mask:0xf
    s_nop 0
    v_add_f32_dpp v128, v128, v128 row_ror:1 row_mask:0xf bank_mask:0xf
    v_add_f32_dpp v129, v129, v129 row_ror:1 row_mask:0xf bank_mask:0xf
    v_mov_b32 v130, v128
    v_mov_b32 v131, v129
    s_nop 1
    v_permlane16_swap_b32 v128, v130
    v_permlane16_swap_b32 v129, v131
    s_nop 0
    v_add_f32 v128, v128, v130
    v_add_f32 v129, v129, v131
    v_lshlrev_b32 v130, 5, v3
    s_lshl_b32 s54, s3, 3
    v_add_u32 v131, s54, v130
    ds_write_b64 v131, v[128:129] offset:4096
    s_waitcnt lgkmcnt(0)
    s_barrier
    ds_read_b128 v[132:135], v130 offset:4096
    ds_read_b128 v[136:139], v130 offset:4112
    s_waitcnt lgkmcnt(0)
    v_add_f32 v128, v132, v134
    v_add_f32 v129, v133, v135
    v_add_f32 v130, v136, v138
    v_add_f32 v131, v137, v139
    v_add_f32 v128, v128, v130
    v_add_f32 v129, v129, v131
    s_mov_b32 s58, 0x3b000000
    v_mul_f32 v128, s58, v128
    v_mul_f32 v129, s58, v129
    v_fma_f32 v129, -v128, v128, v129
    v_max_f32 v129, 0, v129
    v_cvt_pk_bf16_f32 v130, v128, v129
    v_lshlrev_b32 v128, 16, v130
    v_and_b32 v129, 0xffff0000, v130
    v_add_f32 v129, 0x3727c5ac, v129
    v_cvt_pk_bf16_f32 v129, v129, v129
    v_and_b32 v129, 0xffff0000, v129
    v_sqrt_f32 v129, v129
    v_sub_f32 v124, v124, v128
    v_sub_f32 v125, v125, v128
    v_sub_f32 v126, v126, v128
    v_sub_f32 v127, v127, v128
    v_cvt_pk_bf16_f32 v129, v129, v129
    v_and_b32 v129, 0xffff0000, v129
    v_rcp_f32 v129, v129
    v_cvt_pk_bf16_f32 v130, v124, v125
    v_lshlrev_b32 v124, 16, v130
    v_and_b32 v125, 0xffff0000, v130
    v_cvt_pk_bf16_f32 v131, v126, v127
    v_lshlrev_b32 v126, 16, v131
    v_and_b32 v127, 0xffff0000, v131
    v_mul_f32 v124, v124, v129
    v_mul_f32 v125, v125, v129
    v_mul_f32 v126, v126, v129
    v_mul_f32 v127, v127, v129
    v_cvt_pk_bf16_f32 v130, v124, v125
    v_lshlrev_b32 v124, 16, v130
    v_and_b32 v125, 0xffff0000, v130
    v_cvt_pk_bf16_f32 v131, v126, v127
    v_lshlrev_b32 v126, 16, v131
    v_and_b32 v127, 0xffff0000, v131
    v_pk_mul_f32 v[124:125], v[124:125], v[156:157]
    v_pk_mul_f32 v[126:127], v[126:127], v[158:159]
    v_cvt_pk_bf16_f32 v120, v124, v125
    v_lshlrev_b32 v124, 16, v120
    v_and_b32 v125, 0xffff0000, v120
    v_cvt_pk_bf16_f32 v121, v126, v127
    v_lshlrev_b32 v126, 16, v121
    v_and_b32 v127, 0xffff0000, v121
    v_lshlrev_b32 v132, 16, v160
    v_and_b32 v133, 0xffff0000, v160
    v_lshlrev_b32 v134, 16, v161
    v_and_b32 v135, 0xffff0000, v161
    v_pk_add_f32 v[124:125], v[124:125], v[132:133]
    v_pk_add_f32 v[126:127], v[126:127], v[134:135]
    v_cvt_pk_bf16_f32 v136, v124, v125
    v_cvt_pk_bf16_f32 v137, v126, v127
    ds_write_b64 v7, v[136:137]
    ds_read_b128 v[24:27], v8 offset:0
    ds_read_b128 v[28:31], v8 offset:64
    ds_read_b128 v[32:35], v8 offset:128
    ds_read_b128 v[36:39], v8 offset:192
    s_waitcnt lgkmcnt(3)
    v_mfma_f32_16x16x32_bf16 v[104:107], v[24:27], v[40:43], 0
    v_mfma_f32_16x16x32_bf16 v[108:111], v[24:27], v[44:47], 0
    v_mfma_f32_16x16x32_bf16 v[112:115], v[24:27], v[48:51], 0
    v_mfma_f32_16x16x32_bf16 v[116:119], v[24:27], v[52:55], 0
    s_waitcnt lgkmcnt(2)
    v_mfma_f32_16x16x32_bf16 v[104:107], v[28:31], v[56:59], v[104:107]
    v_mfma_f32_16x16x32_bf16 v[108:111], v[28:31], v[60:63], v[108:111]
    v_mfma_f32_16x16x32_bf16 v[112:115], v[28:31], v[64:67], v[112:115]
    v_mfma_f32_16x16x32_bf16 v[116:119], v[28:31], v[68:71], v[116:119]
    s_waitcnt lgkmcnt(1)
    v_mfma_f32_16x16x32_bf16 v[104:107], v[32:35], v[72:75], v[104:107]
    v_mfma_f32_16x16x32_bf16 v[108:111], v[32:35], v[76:79], v[108:111]
    v_mfma_f32_16x16x32_bf16 v[112:115], v[32:35], v[80:83], v[112:115]
    v_mfma_f32_16x16x32_bf16 v[116:119], v[32:35], v[84:87], v[116:119]
    s_waitcnt lgkmcnt(0)
    v_mfma_f32_16x16x32_bf16 v[104:107], v[36:39], v[88:91], v[104:107]
    v_mfma_f32_16x16x32_bf16 v[108:111], v[36:39], v[92:95], v[108:111]
    v_mfma_f32_16x16x32_bf16 v[112:115], v[36:39], v[96:99], v[112:115]
    v_mfma_f32_16x16x32_bf16 v[116:119], v[36:39], v[100:103], v[116:119]
    s_nop 7
    v_mov_b32_dpp v120, v104 quad_perm:[0,1,2,3] row_mask:0x1 bank_mask:0xf
    v_mov_b32_dpp v121, v105 quad_perm:[0,1,2,3] row_mask:0x1 bank_mask:0xf
    v_mov_b32_dpp v120, v108 quad_perm:[0,1,2,3] row_mask:0x2 bank_mask:0xf
    v_mov_b32_dpp v121, v109 quad_perm:[0,1,2,3] row_mask:0x2 bank_mask:0xf
    v_mov_b32_dpp v120, v112 quad_perm:[0,1,2,3] row_mask:0x4 bank_mask:0xf
    v_mov_b32_dpp v121, v113 quad_perm:[0,1,2,3] row_mask:0x4 bank_mask:0xf
    v_mov_b32_dpp v120, v116 quad_perm:[0,1,2,3] row_mask:0x8 bank_mask:0xf
    v_mov_b32_dpp v121, v117 quad_perm:[0,1,2,3] row_mask:0x8 bank_mask:0xf
    ds_write_b32 v9, v120
    ds_write_b32 v9, v121 offset:256
    s_waitcnt lgkmcnt(0)
    s_barrier
    s_cmp_eq_u32 s3, 0
    s_cbranch_scc0 L_end
    v_lshrrev_b32 v120, 3, v2
    v_and_b32 v120, 1, v120
    v_and_b32 v121, 7, v2
    v_lshlrev_b32 v122, 8, v120
    v_lshl_add_u32 v122, v121, 4, v122
    ds_read_b128 v[24:27], v122 offset:2048
    ds_read_b128 v[104:107], v122 offset:2176
    ds_read_b128 v[28:31], v122 offset:2560
    ds_read_b128 v[108:111], v122 offset:2688
    ds_read_b128 v[32:35], v122 offset:3072
    ds_read_b128 v[112:115], v122 offset:3200
    ds_read_b128 v[36:39], v122 offset:3584
    ds_read_b128 v[116:119], v122 offset:3712
    v_lshlrev_b32 v123, 6, v120
    v_lshl_add_u32 v123, v121, 3, v123
    s_waitcnt lgkmcnt(0)
    v_pk_add_f32 v[24:25], v[24:25], v[28:29]
    v_pk_add_f32 v[26:27], v[26:27], v[30:31]
    v_pk_add_f32 v[32:33], v[32:33], v[36:37]
    v_pk_add_f32 v[34:35], v[34:35], v[38:39]
    v_pk_add_f32 v[24:25], v[24:25], v[32:33]
    v_pk_add_f32 v[26:27], v[26:27], v[34:35]
    v_cvt_pk_bf16_f32 v28, v24, v25
    v_lshlrev_b32 v24, 16, v28
    v_and_b32 v25, 0xffff0000, v28
    v_cvt_pk_bf16_f32 v29, v26, v27
    v_lshlrev_b32 v26, 16, v29
    v_and_b32 v27, 0xffff0000, v29
    v_pk_add_f32 v[104:105], v[104:105], v[108:109]
    v_pk_add_f32 v[106:107], v[106:107], v[110:111]
    v_pk_add_f32 v[112:113], v[112:113], v[116:117]
    v_pk_add_f32 v[114:115], v[114:115], v[118:119]
    v_pk_add_f32 v[104:105], v[104:105], v[112:113]
    v_pk_add_f32 v[106:107], v[106:107], v[114:115]
    v_cvt_pk_bf16_f32 v108, v104, v105
    v_lshlrev_b32 v104, 16, v108
    v_and_b32 v105, 0xffff0000, v108
    v_cvt_pk_bf16_f32 v109, v106, v107
    v_lshlrev_b32 v106, 16, v109
    v_and_b32 v107, 0xffff0000, v109
    s_mov_b32 s58, 0xbfb8aa3b
    v_mul_f32 v28, s58, v24
    v_mul_f32 v29, s58, v25
    v_mul_f32 v30, s58, v26
    v_mul_f32 v31, s58, v27
    v_exp_f32 v28, v28
    v_exp_f32 v29, v29
    v_exp_f32 v30, v30
    v_exp_f32 v31, v31
    s_nop 0
    v_add_f32 v28, 1.0, v28
    v_add_f32 v29, 1.0, v29
    v_add_f32 v30, 1.0, v30
    v_add_f32 v31, 1.0, v31
    v_rcp_f32 v28, v28
    v_rcp_f32 v29, v29
    v_rcp_f32 v30, v30
    v_rcp_f32 v31, v31
    s_nop 0
    v_pk_mul_f32 v[24:25], v[24:25], v[28:29]
    v_pk_mul_f32 v[26:27], v[26:27], v[30:31]
    v_cvt_pk_bf16_f32 v28, v24, v25
    v_lshlrev_b32 v24, 16, v28
    v_and_b32 v25, 0xffff0000, v28
    v_cvt_pk_bf16_f32 v29, v26, v27
    v_lshlrev_b32 v26, 16, v29
    v_and_b32 v27, 0xffff0000, v29
    v_pk_mul_f32 v[24:25], v[24:25], v[104:105]
    v_pk_mul_f32 v[26:27], v[26:27], v[106:107]
    v_cvt_pk_bf16_f32 v32, v24, v25
    v_cvt_pk_bf16_f32 v33, v26, v27
    v_min_u32 v32, -2, v32
    v_min_u32 v33, -2, v33
    s_nop 0
    v_mov_b32_dpp v34, v32 quad_perm:[1,1,3,3] row_mask:0xf bank_mask:0xf
    v_mov_b32_dpp v35, v33 quad_perm:[1,1,3,3] row_mask:0xf bank_mask:0xf
    s_mov_b64 exec, 0x5555
    buffer_store_dwordx4 v[32:35], v123, s[84:87], s60 offen sc1
    s_branch L_end
L_tail_dn:
    s_cmp_eq_u32 s3, 0
    s_cbranch_scc0 L_dn_hh
L_poll_50:
    s_add_u32 s54, s56, 0
    buffer_load_dwordx4 v[120:123], v15, s[84:87], s54 offen sc1
    s_add_u32 s54, s56, 4096
    buffer_load_dwordx4 v[124:127], v15, s[84:87], s54 offen sc1
    s_add_u32 s54, s56, 8192
    buffer_load_dwordx4 v[128:131], v15, s[84:87], s54 offen sc1
    s_add_u32 s54, s56, 12288
    buffer_load_dwordx4 v[132:135], v15, s[84:87], s54 offen sc1
    s_add_u32 s54, s56, 16384
    buffer_load_dwordx4 v[136:139], v15, s[84:87], s54 offen sc1
    s_add_u32 s54, s56, 20480
    buffer_load_dwordx4 v[140:143], v15, s[84:87], s54 offen sc1
    s_add_u32 s54, s56, 24576
    buffer_load_dwordx4 v[144:147], v15, s[84:87], s54 offen sc1
    s_add_u32 s54, s56, 28672
    buffer_load_dwordx4 v[148:151], v15, s[84:87], s54 offen sc1
    s_waitcnt vmcnt(0)
    v_max3_u32 v152, v120, v121, v122
    v_max3_u32 v152, v152, v123, v124
    v_max3_u32 v152, v152, v125, v126
    v_max3_u32 v152, v152, v127, v128
    v_max3_u32 v152, v152, v129, v130
    v_max3_u32 v152, v152, v131, v132
    v_max3_u32 v152, v152, v133, v134
    v_max3_u32 v152, v152, v135, v136
    v_max3_u32 v152, v152, v137, v138
    v_max3_u32 v152, v152, v139, v140
    v_max3_u32 v152, v152, v141, v142
    v_max3_u32 v152, v152, v143, v144
    v_max3_u32 v152, v152, v145, v146
    v_max3_u32 v152, v152, v147, v148
    v_max3_u32 v152, v152, v149, v150
    v_max_u32 v152, v152, v151
    v_cmp_eq_u32 vcc, -1, v152
    s_cbranch_vccz L_pdone_51
    s_cmp_eq_u32 s88, 0
    s_cbranch_scc1 L_pdone_51
    s_sub_u32 s88, s88, 1
    s_sleep 1
    s_branch L_poll_50
L_pdone_51:
    v_lshlrev_b32 v152, 16, v16
    v_and_b32 v153, 0xffff0000, v16
    v_lshlrev_b32 v154, 16, v17
    v_and_b32 v155, 0xffff0000, v17
    v_lshlrev_b32 v156, 16, v18
    v_and_b32 v157, 0xffff0000, v18
    v_lshlrev_b32 v158, 16, v19
    v_and_b32 v159, 0xffff0000, v19
    v_pk_add_f32 v[120:121], v[120:121], v[124:125]
    v_pk_add_f32 v[122:123], v[122:123], v[126:127]
    v_pk_add_f32 v[128:129], v[128:129], v[132:133]
    v_pk_add_f32 v[130:131], v[130:131], v[134:135]
    v_pk_add_f32 v[136:137], v[136:137], v[140:141]
    v_pk_add_f32 v[138:139], v[138:139], v[142:143]
    v_pk_add_f32 v[144:145], v[144:145], v[148:149]
    v_pk_add_f32 v[146:147], v[146:147], v[150:151]
    v_pk_add_f32 v[120:121], v[120:121], v[128:129]
    v_pk_add_f32 v[122:123], v[122:123], v[130:131]
    v_pk_add_f32 v[136:137], v[136:137], v[144:145]
    v_pk_add_f32 v[138:139], v[138:139], v[146:147]
    v_pk_add_f32 v[160:161], v[120:121], v[136:137]
    v_pk_add_f32 v[162:163], v[122:123], v[138:139]
    v_cvt_pk_bf16_f32 v22, v160, v161
    v_lshlrev_b32 v160, 16, v22
    v_and_b32 v161, 0xffff0000, v22
    v_cvt_pk_bf16_f32 v23, v162, v163
    v_lshlrev_b32 v162, 16, v23
    v_and_b32 v163, 0xffff0000, v23
    v_pk_mul_f32 v[160:161], v[160:161], v[156:157]
    v_pk_mul_f32 v[162:163], v[162:163], v[158:159]
    v_cvt_pk_bf16_f32 v22, v160, v161
    v_lshlrev_b32 v160, 16, v22
    v_and_b32 v161, 0xffff0000, v22
    v_cvt_pk_bf16_f32 v23, v162, v163
    v_lshlrev_b32 v162, 16, v23
    v_and_b32 v163, 0xffff0000, v23
    v_pk_add_f32 v[160:161], v[160:161], v[152:153]
    v_pk_add_f32 v[162:163], v[162:163], v[154:155]
    v_cvt_pk_bf16_f32 v22, v160, v161
    v_lshlrev_b32 v160, 16, v22
    v_and_b32 v161, 0xffff0000, v22
    v_cvt_pk_bf16_f32 v23, v162, v163
    v_lshlrev_b32 v162, 16, v23
    v_and_b32 v163, 0xffff0000, v23
    v_cvt_pk_bf16_f32 v10, v160, v161
    v_cvt_pk_bf16_f32 v11, v162, v163
L_dn_hh:
L_poll_52:
    buffer_load_dwordx4 v[156:159], v7, s[16:19], s57 offen offset:0 sc1
    buffer_load_dwordx4 v[160:163], v7, s[16:19], s57 offen offset:1024 sc1
    s_waitcnt vmcnt(0)
    v_max3_u32 v22, v156, v157, v158
    v_max3_u32 v22, v22, v159, v160
    v_max3_u32 v22, v22, v161, v162
    v_max_u32 v22, v22, v163
    v_cmp_eq_u32 vcc, -1, v22
    s_cbranch_vccz L_pdone_53
    s_cmp_eq_u32 s88, 0
    s_cbranch_scc1 L_pdone_53
    s_sub_u32 s88, s88, 1
    s_sleep 1
    s_branch L_poll_52
L_pdone_53:
    ds_write_b128 v8, v[156:159]
    ds_write_b128 v8, v[160:163] offset:1024
    ds_read_b128 v[120:123], v12 offset:0
    ds_read_b128 v[124:127], v12 offset:128
    ds_read_b128 v[128:131], v12 offset:256
    ds_read_b128 v[132:135], v12 offset:384
    ds_read_b128 v[136:139], v12 offset:512
    ds_read_b128 v[140:143], v12 offset:640
    ds_read_b128 v[144:147], v12 offset:768
    ds_read_b128 v[148:151], v12 offset:896
    ds_read_b128 v[152:155], v12 offset:1024
    ds_read_b128 v[156:159], v12 offset:1152
    ds_read_b128 v[160:163], v12 offset:1280
    s_waitcnt lgkmcnt(10)
    v_mfma_f32_16x16x32_bf16 v[24:27], v[120:123], v[32:35], 0
    v_mfma_f32_16x16x32_bf16 v[28:31], v[120:123], v[36:39], 0
    s_waitcnt lgkmcnt(9)
    v_mfma_f32_16x16x32_bf16 v[24:27], v[124:127], v[40:43], v[24:27]
    v_mfma_f32_16x16x32_bf16 v[28:31], v[124:127], v[44:47], v[28:31]
    s_waitcnt lgkmcnt(8)
    v_mfma_f32_16x16x32_bf16 v[24:27], v[128:131], v[48:51], v[24:27]
    v_mfma_f32_16x16x32_bf16 v[28:31], v[128:131], v[52:55], v[28:31]
    s_waitcnt lgkmcnt(7)
    v_mfma_f32_16x16x32_bf16 v[24:27], v[132:135], v[56:59], v[24:27]
    v_mfma_f32_16x16x32_bf16 v[28:31], v[132:135], v[60:63], v[28:31]
    s_waitcnt lgkmcnt(6)
    v_mfma_f32_16x16x32_bf16 v[24:27], v[136:139], v[64:67], v[24:27]
    v_mfma_f32_16x16x32_bf16 v[28:31], v[136:139], v[68:71], v[28:31]
    s_waitcnt lgkmcnt(5)
    v_mfma_f32_16x16x32_bf16 v[24:27], v[140:143], v[72:75], v[24:27]
    v_mfma_f32_16x16x32_bf16 v[28:31], v[140:143], v[76:79], v[28:31]
    s_waitcnt lgkmcnt(4)
    v_mfma_f32_16x16x32_bf16 v[24:27], v[144:147], v[80:83], v[24:27]
    v_mfma_f32_16x16x32_bf16 v[28:31], v[144:147], v[84:87], v[28:31]
    s_waitcnt lgkmcnt(3)
    v_mfma_f32_16x16x32_bf16 v[24:27], v[148:151], v[88:91], v[24:27]
    v_mfma_f32_16x16x32_bf16 v[28:31], v[148:151], v[92:95], v[28:31]
    s_waitcnt lgkmcnt(2)
    v_mfma_f32_16x16x32_bf16 v[24:27], v[152:155], v[96:99], v[24:27]
    v_mfma_f32_16x16x32_bf16 v[28:31], v[152:155], v[100:103], v[28:31]
    s_waitcnt lgkmcnt(1)
    v_mfma_f32_16x16x32_bf16 v[24:27], v[156:159], v[104:107], v[24:27]
    v_mfma_f32_16x16x32_bf16 v[28:31], v[156:159], v[108:111], v[28:31]
    s_waitcnt lgkmcnt(0)
    v_mfma_f32_16x16x32_bf16 v[24:27], v[160:163], v[112:115], v[24:27]
    v_mfma_f32_16x16x32_bf16 v[28:31], v[160:163], v[116:119], v[28:31]
    s_nop 7
    v_mov_b32_dpp v22, v24 quad_perm:[0,1,2,3] row_mask:0x1 bank_mask:0xf
    v_mov_b32_dpp v23, v25 quad_perm:[0,1,2,3] row_mask:0x1 bank_mask:0xf
    v_mov_b32_dpp v22, v28 quad_perm:[0,1,2,3] row_mask:0x2 bank_mask:0xf
    v_mov_b32_dpp v23, v29 quad_perm:[0,1,2,3] row_mask:0x2 bank_mask:0xf
    ds_write_b32 v9, v22
    ds_write_b32 v9, v23 offset:256
    s_waitcnt lgkmcnt(0)
    s_barrier
    s_cmp_eq_u32 s3, 0
    s_cbranch_scc0 L_end
    v_lshlrev_b32 v22, 8, v13
    v_lshl_add_u32 v22, v14, 4, v22
    ds_read_b128 v[120:123], v22 offset:2048
    ds_read_b128 v[124:127], v22 offset:2560
    ds_read_b128 v[128:131], v22 offset:3072
    ds_read_b128 v[132:135], v22 offset:3584
    v_lshlrev_b32 v136, 16, v20
    v_and_b32 v137, 0xffff0000, v20
    v_lshlrev_b32 v138, 16, v21
    v_and_b32 v139, 0xffff0000, v21
    v_lshlrev_b32 v140, 16, v10
    v_and_b32 v141, 0xffff0000, v10
    v_lshlrev_b32 v142, 16, v11
    v_and_b32 v143, 0xffff0000, v11
    v_lshlrev_b32 v23, 10, v13
    v_lshl_add_u32 v23, v14, 3, v23
    s_lshl_b32 s54, s59, 6
    s_waitcnt lgkmcnt(0)
    v_pk_add_f32 v[120:121], v[120:121], v[124:125]
    v_pk_add_f32 v[122:123], v[122:123], v[126:127]
    v_pk_add_f32 v[128:129], v[128:129], v[132:133]
    v_pk_add_f32 v[130:131], v[130:131], v[134:135]
    v_pk_add_f32 v[120:121], v[120:121], v[128:129]
    v_pk_add_f32 v[122:123], v[122:123], v[130:131]
    v_cvt_pk_bf16_f32 v124, v120, v121
    v_lshlrev_b32 v120, 16, v124
    v_and_b32 v121, 0xffff0000, v124
    v_cvt_pk_bf16_f32 v125, v122, v123
    v_lshlrev_b32 v122, 16, v125
    v_and_b32 v123, 0xffff0000, v125
    v_pk_mul_f32 v[120:121], v[120:121], v[136:137]
    v_pk_mul_f32 v[122:123], v[122:123], v[138:139]
    v_cvt_pk_bf16_f32 v124, v120, v121
    v_lshlrev_b32 v120, 16, v124
    v_and_b32 v121, 0xffff0000, v124
    v_cvt_pk_bf16_f32 v125, v122, v123
    v_lshlrev_b32 v122, 16, v125
    v_and_b32 v123, 0xffff0000, v125
    v_pk_add_f32 v[120:121], v[120:121], v[140:141]
    v_pk_add_f32 v[122:123], v[122:123], v[142:143]
    v_cvt_pk_bf16_f32 v128, v120, v121
    v_cvt_pk_bf16_f32 v129, v122, v123
    s_mov_b64 exec, 0xffff
    buffer_store_dwordx2 v[128:129], v23, s[72:75], s54 offen
    s_branch L_end
L_end:
    s_endpgm
L_codeend:
.section .rodata,"a"
.p2align 6
.amdhsa_kernel adaLN_cond__mha_block_cached__glu_gated_swiglu__decode_kernel
  .amdhsa_next_free_vgpr 168
  .amdhsa_next_free_sgpr 102
  .amdhsa_accum_offset 168
  .amdhsa_group_segment_fixed_size 0
  .amdhsa_kernarg_size 112
  .amdhsa_user_sgpr_count 2
  .amdhsa_user_sgpr_kernarg_segment_ptr 1
  .amdhsa_system_sgpr_workgroup_id_x 1
  .amdhsa_float_denorm_mode_32 3
.end_amdhsa_kernel
```
